```python
import torch

def _softmax(x, axis=-1):
    return torch.softmax(x, dim=axis)
def _gelu(x):
    return torch.nn.functional.gelu(x, approximate="tanh")
def _silu(x):
    return torch.nn.functional.silu(x)
def _sigmoid(x):
    return torch.sigmoid(x)
def _layernorm(x, axis=-1, eps=1e-5):
    m = x.mean(dim=axis, keepdim=True)
    v = x.var(dim=axis, keepdim=True, unbiased=False)
    return (x - m) / torch.sqrt(v + eps)
def _scatter_add(tgt, idx, src, axis=0):
    return tgt.clone().index_add_(axis, idx, src)
def _segment_sum(src, seg, n):
    out = torch.zeros((n,) + src.shape[1:], dtype=src.dtype)
    return out.index_add_(0, seg, src)
def _pad(x, pw):
    flat = tuple(v for pair in reversed(pw) for v in pair)
    return torch.nn.functional.pad(x, flat)

kernel_name = 'concat_heads__gqa_block_cached__mha_block_cached__near_ridge'

def setup_inputs():

    _w = (lambda a: (lambda t: t.to(torch.bfloat16) if t.is_floating_point() else t)(torch.as_tensor(a)))
    def _A_setup():
        B, Sq, D = 16, 32, 1024
        Hq, Hkv, Sk, Dh = 32, 4, 32, 128
        assert Hq % Hkv == 0, (Hq, Hkv)
        return {
            "x": _w((lambda *s: torch.randn(*s, dtype=torch.bfloat16) * 0.8)(B, Sq, D)),
            "k_cache": _w((lambda *s: torch.randn(*s, dtype=torch.bfloat16) * 0.8)(B, Hkv, Sk, Dh)),
            "v_cache": _w((lambda *s: torch.randn(*s, dtype=torch.bfloat16) * 0.05)(B, Hkv, Sk, Dh)),
            "wq": _w((lambda *s: torch.randn(*s, dtype=torch.bfloat16) * 0.8)(D, Hq * Dh) * (D ** -0.5)),
            "wo": _w((lambda *s: torch.randn(*s, dtype=torch.bfloat16) * 0.05)(Hq * Dh, D) * ((Hq * Dh) ** -0.5)),
        }
    _A_in = _A_setup()

    def _B_setup():
        B, Sq, D = 16, 32, 1024
        H, Sk, Dh = 32, 32, 128
        return {
            "x": _w((lambda *s: torch.randn(*s, dtype=torch.bfloat16) * 0.8)(B, Sq, D)),
            "k_cache": _w((lambda *s: torch.randn(*s, dtype=torch.bfloat16) * 0.8)(B, H, Sk, Dh)),
            "v_cache": _w((lambda *s: torch.randn(*s, dtype=torch.bfloat16) * 0.05)(B, H, Sk, Dh)),
            "wq": _w((lambda *s: torch.randn(*s, dtype=torch.bfloat16) * 0.8)(D, H * Dh) * (D ** -0.5)),
            "wo": _w((lambda *s: torch.randn(*s, dtype=torch.bfloat16) * 0.05)(H * Dh, D) * ((H * Dh) ** -0.5)),
        }
    _B_in = _B_setup()

    return {
        "A_x": _A_in["x"],
        "A_k_cache": _A_in["k_cache"],
        "A_v_cache": _A_in["v_cache"],
        "A_wq": _A_in["wq"],
        "A_wo": _A_in["wo"],
        "B_x": _B_in["x"],
        "B_k_cache": _B_in["k_cache"],
        "B_v_cache": _B_in["v_cache"],
        "B_wq": _B_in["wq"],
        "B_wo": _B_in["wo"],
    }

def reference(A_x, A_k_cache, A_v_cache, A_wq, A_wo, B_x, B_k_cache, B_v_cache, B_wq, B_wo):
    def _A_ref(x, k_cache, v_cache, wq, wo):
        B, Sq, D = x.shape
        Hq, Dh = 32, 128
        Hkv = k_cache.shape[1]
        rep = Hq // Hkv
        q = (lambda x, *d: x.permute(*d))((x @ wq).reshape(B, Sq, Hq, Dh), 0, 2, 1, 3)
        k = (lambda x, n, axis: torch.repeat_interleave(x, n, dim=axis))(k_cache, rep, axis=1)
        v = (lambda x, n, axis: torch.repeat_interleave(x, n, dim=axis))(v_cache, rep, axis=1)
        scores = torch.einsum("bhqd,bhkd->bhqk", q, k) * (Dh ** -0.5)
        p = _softmax(scores, axis=-1)
        o = torch.einsum("bhqk,bhkd->bhqd", p, v)
        return (lambda x, *d: x.permute(*d))(o, 0, 2, 1, 3).reshape(B, Sq, Hq * Dh) @ wo

    def _B_ref(x, k_cache, v_cache, wq, wo):
        B, Sq, D = x.shape
        H, Dh = 32, 128
        q = (lambda x, *d: x.permute(*d))((x @ wq).reshape(B, Sq, H, Dh), 0, 2, 1, 3)
        scores = torch.einsum("bhqd,bhkd->bhqk", q, k_cache) * (Dh ** -0.5)
        p = _softmax(scores, axis=-1)
        o = torch.einsum("bhqk,bhkd->bhqd", p, v_cache)
        return (lambda x, *d: x.permute(*d))(o, 0, 2, 1, 3).reshape(B, Sq, H * Dh) @ wo

    a = _A_ref(A_x, A_k_cache, A_v_cache, A_wq, A_wo)
    b = _B_ref(B_x, B_k_cache, B_v_cache, B_wq, B_wo)
    return torch.concatenate([a, b], axis=-1)
```

```asm
; @launch grid=(256,1,1) block=(512,1,1) lds=149504
.amdgcn_target "amdgcn-amd-amdhsa--gfx950"
.text
.globl concat_heads__gqa_block_cached__mha_block_cached__near_ridge_kernel
.p2align 8
.type concat_heads__gqa_block_cached__mha_block_cached__near_ridge_kernel,@function
concat_heads__gqa_block_cached__mha_block_cached__near_ridge_kernel:
    s_cmp_ge_u32 s2, 256
    s_cbranch_scc1 L_end
    s_bfe_u32 s17, s2, 0x10002
    s_and_b32 s18, s2, 3
    s_lshr_b32 s19, s2, 6
    s_bfe_u32 s20, s2, 0x30003
    s_mul_i32 s3, s17, 40
    s_add_u32 s4, s0, s3
    s_addc_u32 s5, s1, 0
    s_load_dwordx8 s[24:31], s[4:5], 0
    s_load_dwordx2 s[32:33], s[4:5], 32
    s_load_dwordx4 s[36:39], s[0:1], 80
    s_load_dwordx2 s[44:45], s[0:1], 96
    v_lshrrev_b32 v1, 6, v0
    v_and_b32 v0, 63, v0
    v_readfirstlane_b32 s16, v1
    s_lshl_b32 s21, s17, 2
    s_add_u32 s21, s21, s19
    s_lshl_b32 s21, s21, 5
    s_mov_b32 s92, 0x1000000
    s_mov_b32 s46, 0x10000000
    s_mov_b32 s47, 0x20000
    s_mov_b32 s101, 0x76534210
    s_cmp_eq_u32 s19, 1
    s_cselect_b32 s101, 0x76453210, s101
    s_cmp_eq_u32 s19, 2
    s_cselect_b32 s101, 0x75643120, s101
    s_cmp_eq_u32 s19, 3
    s_cselect_b32 s101, 0x67542310, s101
    v_lshlrev_b32 v13, 2, v0
    v_mov_b32 v12, 0
    s_cmp_ge_u32 s16, 4
    s_cbranch_scc0 L_compute
    s_setprio 2
    s_and_b32 s22, s16, 3
    v_cmp_eq_u32 vcc, 4, v0
    v_cndmask_b32 v12, v12, -3, vcc
    ds_write_b32 v13, v12
    s_lshl_b32 s23, s19, 2
    s_lshl_b32 s34, s18, 3
    s_add_u32 s34, s34, s20
    v_lshrrev_b32 v1, 3, v0
    v_lshrrev_b32 v2, 4, v0
    v_and_b32 v3, 7, v0
    v_xor_b32 v3, v3, v2
    v_lshlrev_b32 v3, 4, v3
    v_xor_b32 v4, 64, v3
    v_and_b32 v5, 15, v0
    v_lshlrev_b32 v6, 2, v2
    v_xor_b32 v6, v5, v6
    v_lshlrev_b32 v6, 4, v6
    s_lshl_b32 s3, s23, 16
    v_lshl_add_u32 v7, v1, 11, s3
    v_add_u32 v8, 0, v7
    v_add_u32 v8, v8, v3
    v_add_u32 v9, 15360, v7
    v_add_u32 v9, v9, v4
    v_add_u32 v10, 30720, v7
    v_add_u32 v10, v10, v3
    v_add_u32 v11, 46080, v7
    v_add_u32 v11, v11, v4
    s_lshl_b32 s3, s34, 8
    v_lshl_add_u32 v7, v2, 13, s3
    v_add_u32 v7, v7, v6
    v_add_u32 v12, 0, v7
    v_add_u32 v13, 31744, v7
    v_add_u32 v14, 63488, v7
    v_add_u32 v15, 95232, v7
    s_cmp_eq_u32 s17, 0
    s_cselect_b32 s35, 0, 8192
    s_cselect_b32 s14, 19, 22
    s_cselect_b32 s58, 15, 18
    s_cselect_b32 s59, 13, 16
    s_lshl_b32 s89, 1, s58
    s_lshl_b32 s58, s23, s58
    s_lshl_b32 s59, s18, s59
    s_add_u32 s58, s58, s59
    s_lshl_b32 s3, s18, 21
    s_lshl_b32 s59, s20, 8
    s_add_u32 s3, s3, s59
    v_lshl_add_u32 v7, v2, 11, s3
    v_add_u32 v7, v7, v6
    v_add_u32 v20, 0, v7
    v_add_u32 v21, 7168, v7
    v_add_u32 v22, 14336, v7
    v_add_u32 v23, 21504, v7
    s_mul_i32 s59, s20, s35
    s_add_u32 s58, s58, s59
    v_lshl_add_u32 v7, v2, 8, s58
    v_lshl_add_u32 v5, v1, 8, s58
    v_add_u32 v24, 0, v5
    v_add_u32 v24, v24, v3
    v_add_u32 v25, 1024, v5
    v_add_u32 v25, v25, v4
    v_add_u32 v26, 2048, v5
    v_add_u32 v26, v26, v3
    v_add_u32 v27, 3072, v5
    v_add_u32 v27, v27, v4
    v_add_u32 v16, v7, v6
    v_lshl_add_u32 v28, v0, 7, s58
    s_lshl_b32 s3, s34, 8
    v_lshl_add_u32 v44, v0, 13, s3
    s_lshl_b32 s3, s23, 16
    s_lshr_b32 s42, s20, 2
    s_lshl_b32 s42, s42, 17
    s_add_u32 s3, s3, s42
    v_lshl_add_u32 v45, v0, 11, s3
    s_lshl_b32 s3, s18, 21
    s_lshl_b32 s42, s20, 8
    s_add_u32 s3, s3, s42
    v_lshl_add_u32 v46, v0, 11, s3
    s_add_u32 s3, s19, s20
    s_and_b32 s3, s3, 3
    s_mov_b32 s40, 0x86534210
    s_mov_b32 s41, 0xfedbca97
    s_cmp_eq_u32 s3, 1
    s_cselect_b32 s40, 0x76453201, s40
    s_cselect_b32 s41, 0xfecdba89, s41
    s_cmp_eq_u32 s3, 2
    s_cselect_b32 s40, 0x75643120, s40
    s_cselect_b32 s41, 0xfdecb9a8, s41
    s_cmp_eq_u32 s3, 3
    s_cselect_b32 s40, 0x67542310, s40
    s_cselect_b32 s41, 0xefdcab98, s41
    s_sub_u32 s3, s3, 1
    s_and_b32 s3, s3, 3
    s_add_u32 s100, s3, 1
    s_and_b32 s100, s100, 3
    s_cmp_eq_u32 s100, s22
    s_cselect_b32 s100, 0, 99
    s_add_u32 s56, s3, 0
    s_and_b32 s56, s56, 3
    s_cmp_eq_u32 s56, s22
    s_cselect_b32 s56, 0, 99
    s_lshl_b32 s3, s22, 2
    s_lshr_b64 s[40:41], s[40:41], s3
    s_lshl_b32 s57, s22, 15
    s_add_u32 s57, s57, 2048
    v_and_b32 v30, 3, v0
    v_lshlrev_b32 v30, 8, v30
    v_add_u32 v30, 256, v30
    v_cmp_lt_u32 vcc, 3, v0
    v_cndmask_b32 v30, v30, 16, vcc
    v_mov_b32 v31, s3
    v_mov_b32 v33, 16
    s_waitcnt lgkmcnt(0)
    s_barrier
    s_mov_b32 s88, s29
    s_sub_u32 s29, s22, 3
    s_mov_b32 s4, s24
    s_and_b32 s5, s25, 0xffff
    s_mov_b32 s6, 0x100000
    s_mov_b32 s7, 0x20000
    s_mov_b32 s8, s30
    s_and_b32 s9, s31, 0xffff
    s_mov_b32 s10, 0x800000
    s_mov_b32 s11, 0x20000
    s_lshl_b32 s14, 1, s14
    s_mov_b32 s12, s26
    s_and_b32 s13, s27, 0xffff
    s_mov_b32 s15, 0x20000
    s_mov_b32 s48, s28
    s_and_b32 s49, s88, 0xffff
    s_mov_b32 s50, s14
    s_mov_b32 s51, 0x20000
    s_mov_b32 s52, s32
    s_and_b32 s53, s33, 0xffff
    s_mov_b32 s54, 0x800000
    s_mov_b32 s55, 0x20000
L_l1:
    s_branch L_pe0
L_pw0:
    s_sub_u32 s92, s92, 1
    s_cmp_lt_i32 s92, 0
    s_cbranch_scc1 L_px0
    s_sleep 1
L_pe0:
    ds_read_b32 v32, v30
    s_waitcnt lgkmcnt(0)
    v_cmp_gt_i32 vcc, s29, v32
    s_cbranch_vccnz L_pw0
L_px0:
    s_cmp_lg_u32 s100, 2
    s_cbranch_scc1 L_x2
    s_add_u32 s3, s21, s34
    v_mov_b32 v36, s3
    s_getreg_b32 s3, hwreg(HW_REG_XCC_ID, 0, 4)
    s_or_b32 s3, s3, 16
    v_mov_b32 v37, s3
    s_mov_b64 exec, 1
    s_waitcnt vmcnt(0)
    global_store_byte v36, v37, s[38:39] sc1
    s_mov_b64 exec, -1
L_x2:
    s_cmp_lg_u32 s29, 11
    s_cbranch_scc1 L_nfl
    s_load_dwordx8 s[80:87], s[38:39], s21 glc
L_nfl:
    s_mul_i32 s3, s20, 0
    s_mul_i32 s42, s19, 0
    s_add_u32 s3, s3, s42
    s_add_u32 s3, s3, s40
    s_and_b32 s3, s3, 15
    s_lshr_b64 s[40:41], s[40:41], 16
    s_lshl_b32 s42, s3, 19
    s_lshl_b32 s43, s3, 7
    s_add_u32 m0, s57, 0
    s_nop 0
    buffer_load_dwordx4 v12, s[8:11], s42 offen offset:0  lds
    buffer_load_dwordx4 v13, s[8:11], s42 offen offset:1024  lds
    buffer_load_dwordx4 v14, s[8:11], s42 offen offset:2048  lds
    buffer_load_dwordx4 v15, s[8:11], s42 offen offset:3072  lds
    s_add_u32 m0, s57, 4096
    s_add_u32 s42, s42, 131072
    buffer_load_dwordx4 v12, s[8:11], s42 offen offset:0  lds
    buffer_load_dwordx4 v13, s[8:11], s42 offen offset:1024  lds
    buffer_load_dwordx4 v14, s[8:11], s42 offen offset:2048  lds
    buffer_load_dwordx4 v15, s[8:11], s42 offen offset:3072  lds
    s_add_u32 m0, s57, 8192
    s_add_u32 s42, s42, 131072
    buffer_load_dwordx4 v12, s[8:11], s42 offen offset:0  lds
    buffer_load_dwordx4 v13, s[8:11], s42 offen offset:1024  lds
    buffer_load_dwordx4 v14, s[8:11], s42 offen offset:2048  lds
    buffer_load_dwordx4 v15, s[8:11], s42 offen offset:3072  lds
    s_add_u32 s3, s29, 1
    v_mov_b32 v32, s3
    ds_write_b32 v33, v32
    s_add_u32 m0, s57, 12288
    s_add_u32 s42, s42, 131072
    buffer_load_dwordx4 v12, s[8:11], s42 offen offset:0  lds
    buffer_load_dwordx4 v13, s[8:11], s42 offen offset:1024  lds
    buffer_load_dwordx4 v14, s[8:11], s42 offen offset:2048  lds
    buffer_load_dwordx4 v15, s[8:11], s42 offen offset:3072  lds
    s_add_u32 m0, s57, 16384
    s_nop 0
    buffer_load_dwordx4 v8, s[4:7], s43 offen offset:0  lds
    buffer_load_dwordx4 v9, s[4:7], s43 offen offset:1024  lds
    buffer_load_dwordx4 v10, s[4:7], s43 offen offset:2048  lds
    buffer_load_dwordx4 v11, s[4:7], s43 offen offset:3072  lds
    s_add_u32 m0, s57, 20480
    s_add_u32 s43, s43, 65536
    buffer_load_dwordx4 v8, s[4:7], s43 offen offset:0  lds
    buffer_load_dwordx4 v9, s[4:7], s43 offen offset:1024  lds
    buffer_load_dwordx4 v10, s[4:7], s43 offen offset:2048  lds
    buffer_load_dwordx4 v11, s[4:7], s43 offen offset:3072  lds
    s_add_u32 m0, s57, 24576
    s_add_u32 s43, s43, 65536
    buffer_load_dwordx4 v8, s[4:7], s43 offen offset:0  lds
    buffer_load_dwordx4 v9, s[4:7], s43 offen offset:1024  lds
    buffer_load_dwordx4 v10, s[4:7], s43 offen offset:2048  lds
    buffer_load_dwordx4 v11, s[4:7], s43 offen offset:3072  lds
    s_add_u32 m0, s57, 28672
    s_add_u32 s43, s43, 65536
    buffer_load_dwordx4 v8, s[4:7], s43 offen offset:0  lds
    buffer_load_dwordx4 v9, s[4:7], s43 offen offset:1024  lds
    buffer_load_dwordx4 v10, s[4:7], s43 offen offset:2048  lds
    buffer_load_dwordx4 v11, s[4:7], s43 offen offset:3072  lds
    s_cmp_gt_u32 s56, 3
    s_cbranch_scc1 L_np
    s_and_b32 s3, s56, 1
    s_cmp_gt_u32 s56, 1
    s_cbranch_scc1 L_pv
    s_lshl_b32 s42, s3, 7
    s_mov_b32 m0, 133120
    s_nop 0
    buffer_load_dwordx4 v24, s[12:15], s42 offen offset:0  lds
    buffer_load_dwordx4 v25, s[12:15], s42 offen offset:1024  lds
    buffer_load_dwordx4 v26, s[12:15], s42 offen offset:2048  lds
    buffer_load_dwordx4 v27, s[12:15], s42 offen offset:3072  lds
    s_mov_b32 m0, 137216
    s_add_u32 s42, s42, s89
    buffer_load_dwordx4 v24, s[12:15], s42 offen offset:0  lds
    buffer_load_dwordx4 v25, s[12:15], s42 offen offset:1024  lds
    buffer_load_dwordx4 v26, s[12:15], s42 offen offset:2048  lds
    buffer_load_dwordx4 v27, s[12:15], s42 offen offset:3072  lds
    s_mov_b32 m0, 141312
    s_add_u32 s42, s42, s89
    buffer_load_dwordx4 v24, s[12:15], s42 offen offset:0  lds
    buffer_load_dwordx4 v25, s[12:15], s42 offen offset:1024  lds
    buffer_load_dwordx4 v26, s[12:15], s42 offen offset:2048  lds
    buffer_load_dwordx4 v27, s[12:15], s42 offen offset:3072  lds
    s_mov_b32 m0, 145408
    s_add_u32 s42, s42, s89
    buffer_load_dwordx4 v24, s[12:15], s42 offen offset:0  lds
    buffer_load_dwordx4 v25, s[12:15], s42 offen offset:1024  lds
    buffer_load_dwordx4 v26, s[12:15], s42 offen offset:2048  lds
    buffer_load_dwordx4 v27, s[12:15], s42 offen offset:3072  lds
    s_branch L_pd
L_pv:
    s_lshl_b32 s42, s3, 12
    s_mov_b32 m0, 133120
    s_nop 0
    buffer_load_dwordx4 v16, s[48:51], s42 offen offset:0  lds
    buffer_load_dwordx4 v16, s[48:51], s42 offen offset:1024  lds
    buffer_load_dwordx4 v16, s[48:51], s42 offen offset:2048  lds
    buffer_load_dwordx4 v16, s[48:51], s42 offen offset:3072  lds
    s_mov_b32 m0, 137216
    s_add_u32 s42, s42, s89
    buffer_load_dwordx4 v16, s[48:51], s42 offen offset:0  lds
    buffer_load_dwordx4 v16, s[48:51], s42 offen offset:1024  lds
    buffer_load_dwordx4 v16, s[48:51], s42 offen offset:2048  lds
    buffer_load_dwordx4 v16, s[48:51], s42 offen offset:3072  lds
    s_mov_b32 m0, 141312
    s_add_u32 s42, s42, s89
    buffer_load_dwordx4 v16, s[48:51], s42 offen offset:0  lds
    buffer_load_dwordx4 v16, s[48:51], s42 offen offset:1024  lds
    buffer_load_dwordx4 v16, s[48:51], s42 offen offset:2048  lds
    buffer_load_dwordx4 v16, s[48:51], s42 offen offset:3072  lds
    s_mov_b32 m0, 145408
    s_add_u32 s42, s42, s89
    buffer_load_dwordx4 v16, s[48:51], s42 offen offset:0  lds
    buffer_load_dwordx4 v16, s[48:51], s42 offen offset:1024  lds
    buffer_load_dwordx4 v16, s[48:51], s42 offen offset:2048  lds
    buffer_load_dwordx4 v16, s[48:51], s42 offen offset:3072  lds
L_pd:
    s_add_u32 s56, s56, 1
L_np:
    s_add_u32 s100, s100, 1
    s_cmp_lg_u32 s100, 1
    s_cbranch_scc1 L_ns0
    s_add_u32 s3, s21, s34
    s_lshl_b32 s3, s3, 16
    s_add_u32 s3, s3, 32768
    v_lshlrev_b32 v36, 4, v0
    s_and_b32 s45, s45, 0xffff
    v_mov_b32 v40, -1
    v_mov_b32 v41, -1
    v_mov_b32 v42, -1
    v_mov_b32 v43, -1
    buffer_store_dwordx4 v[40:43], v36, s[44:47], s3 offen offset:0 sc1
    buffer_store_dwordx4 v[40:43], v36, s[44:47], s3 offen offset:1024 sc1
    buffer_store_dwordx4 v[40:43], v36, s[44:47], s3 offen offset:2048 sc1
    buffer_store_dwordx4 v[40:43], v36, s[44:47], s3 offen offset:3072 sc1
    s_add_u32 s3, s3, 4096
    buffer_store_dwordx4 v[40:43], v36, s[44:47], s3 offen offset:0 sc1
    buffer_store_dwordx4 v[40:43], v36, s[44:47], s3 offen offset:1024 sc1
    buffer_store_dwordx4 v[40:43], v36, s[44:47], s3 offen offset:2048 sc1
    buffer_store_dwordx4 v[40:43], v36, s[44:47], s3 offen offset:3072 sc1
    s_add_u32 s3, s3, 4096
    buffer_store_dwordx4 v[40:43], v36, s[44:47], s3 offen offset:0 sc1
    buffer_store_dwordx4 v[40:43], v36, s[44:47], s3 offen offset:1024 sc1
    buffer_store_dwordx4 v[40:43], v36, s[44:47], s3 offen offset:2048 sc1
    buffer_store_dwordx4 v[40:43], v36, s[44:47], s3 offen offset:3072 sc1
    s_add_u32 s3, s29, 4
    v_mov_b32 v35, s3
    s_waitcnt vmcnt(12)
    s_branch L_nw
L_ns0:
    s_cmp_lg_u32 s100, 2
    s_cbranch_scc1 L_ns1
    s_add_u32 s3, s21, s34
    s_lshl_b32 s3, s3, 16
    s_add_u32 s3, s3, 45056
    v_lshlrev_b32 v36, 4, v0
    s_and_b32 s45, s45, 0xffff
    v_mov_b32 v40, -1
    v_mov_b32 v41, -1
    v_mov_b32 v42, -1
    v_mov_b32 v43, -1
    buffer_store_dwordx4 v[40:43], v36, s[44:47], s3 offen offset:0 sc1
    buffer_store_dwordx4 v[40:43], v36, s[44:47], s3 offen offset:1024 sc1
    buffer_store_dwordx4 v[40:43], v36, s[44:47], s3 offen offset:2048 sc1
    buffer_store_dwordx4 v[40:43], v36, s[44:47], s3 offen offset:3072 sc1
    s_add_u32 s3, s3, 4096
    buffer_store_dwordx4 v[40:43], v36, s[44:47], s3 offen offset:0 sc1
    buffer_store_dwordx4 v[40:43], v36, s[44:47], s3 offen offset:1024 sc1
    buffer_store_dwordx4 v[40:43], v36, s[44:47], s3 offen offset:2048 sc1
    buffer_store_dwordx4 v[40:43], v36, s[44:47], s3 offen offset:3072 sc1
    s_add_u32 s3, s3, 4096
    buffer_store_dwordx4 v[40:43], v36, s[44:47], s3 offen offset:0 sc1
    buffer_store_dwordx4 v[40:43], v36, s[44:47], s3 offen offset:1024 sc1
    buffer_store_dwordx4 v[40:43], v36, s[44:47], s3 offen offset:2048 sc1
    buffer_store_dwordx4 v[40:43], v36, s[44:47], s3 offen offset:3072 sc1
    s_add_u32 s3, s3, 4096
    buffer_store_dwordx4 v[40:43], v36, s[44:47], s3 offen sc1
    s_add_u32 s3, s29, 4
    v_mov_b32 v35, s3
    s_waitcnt vmcnt(13)
    s_branch L_nw
L_ns1:
L_ns:
    s_add_u32 s3, s29, 4
    v_mov_b32 v35, s3
    s_waitcnt vmcnt(0)
L_nw:
    s_cmp_eq_u32 s29, 11
    s_cbranch_scc1 L_fchk
L_fret:
    ds_write_b32 v31, v35
    s_add_u32 s29, s29, 4
    s_cmp_lt_i32 s29, 13
    s_cbranch_scc1 L_l1
L_l2:
    s_branch L_pe1
L_pw1:
    s_sub_u32 s92, s92, 1
    s_cmp_lt_i32 s92, 0
    s_cbranch_scc1 L_px1
    s_sleep 1
L_pe1:
    ds_read_b32 v32, v30
    s_waitcnt lgkmcnt(0)
    v_cmp_gt_i32 vcc, s29, v32
    s_cbranch_vccnz L_pw1
L_px1:
    s_sub_u32 s3, s29, 13
    s_lshl_b32 s3, s3, 2
    s_lshr_b32 s42, s101, s3
    s_and_b32 s42, s42, 7
    s_xor_b32 s42, s42, s20
    s_lshl_b32 s42, s42, 18
    s_add_u32 m0, s57, 0
    s_nop 0
    buffer_load_dwordx4 v20, s[52:55], s42 offen offset:0  lds
    buffer_load_dwordx4 v21, s[52:55], s42 offen offset:1024  lds
    buffer_load_dwordx4 v22, s[52:55], s42 offen offset:2048  lds
    buffer_load_dwordx4 v23, s[52:55], s42 offen offset:3072  lds
    s_add_u32 m0, s57, 4096
    s_add_u32 s42, s42, 32768
    buffer_load_dwordx4 v20, s[52:55], s42 offen offset:0  lds
    buffer_load_dwordx4 v21, s[52:55], s42 offen offset:1024  lds
    buffer_load_dwordx4 v22, s[52:55], s42 offen offset:2048  lds
    buffer_load_dwordx4 v23, s[52:55], s42 offen offset:3072  lds
    s_add_u32 m0, s57, 8192
    s_add_u32 s42, s42, 32768
    buffer_load_dwordx4 v20, s[52:55], s42 offen offset:0  lds
    buffer_load_dwordx4 v21, s[52:55], s42 offen offset:1024  lds
    buffer_load_dwordx4 v22, s[52:55], s42 offen offset:2048  lds
    buffer_load_dwordx4 v23, s[52:55], s42 offen offset:3072  lds
    s_add_u32 s3, s29, 1
    v_mov_b32 v32, s3
    ds_write_b32 v33, v32
    s_add_u32 m0, s57, 12288
    s_add_u32 s42, s42, 32768
    buffer_load_dwordx4 v20, s[52:55], s42 offen offset:0  lds
    buffer_load_dwordx4 v21, s[52:55], s42 offen offset:1024  lds
    buffer_load_dwordx4 v22, s[52:55], s42 offen offset:2048  lds
    buffer_load_dwordx4 v23, s[52:55], s42 offen offset:3072  lds
    s_add_u32 m0, s57, 16384
    s_add_u32 s42, s42, 32768
    buffer_load_dwordx4 v20, s[52:55], s42 offen offset:0  lds
    buffer_load_dwordx4 v21, s[52:55], s42 offen offset:1024  lds
    buffer_load_dwordx4 v22, s[52:55], s42 offen offset:2048  lds
    buffer_load_dwordx4 v23, s[52:55], s42 offen offset:3072  lds
    s_add_u32 m0, s57, 20480
    s_add_u32 s42, s42, 32768
    buffer_load_dwordx4 v20, s[52:55], s42 offen offset:0  lds
    buffer_load_dwordx4 v21, s[52:55], s42 offen offset:1024  lds
    buffer_load_dwordx4 v22, s[52:55], s42 offen offset:2048  lds
    buffer_load_dwordx4 v23, s[52:55], s42 offen offset:3072  lds
    s_add_u32 m0, s57, 24576
    s_add_u32 s42, s42, 32768
    buffer_load_dwordx4 v20, s[52:55], s42 offen offset:0  lds
    buffer_load_dwordx4 v21, s[52:55], s42 offen offset:1024  lds
    buffer_load_dwordx4 v22, s[52:55], s42 offen offset:2048  lds
    buffer_load_dwordx4 v23, s[52:55], s42 offen offset:3072  lds
    s_add_u32 m0, s57, 28672
    s_add_u32 s42, s42, 32768
    buffer_load_dwordx4 v20, s[52:55], s42 offen offset:0  lds
    buffer_load_dwordx4 v21, s[52:55], s42 offen offset:1024  lds
    buffer_load_dwordx4 v22, s[52:55], s42 offen offset:2048  lds
    buffer_load_dwordx4 v23, s[52:55], s42 offen offset:3072  lds
    s_add_u32 s3, s29, 4
    v_mov_b32 v35, s3
    s_waitcnt vmcnt(0)
    ds_write_b32 v31, v35
    s_add_u32 s29, s29, 4
    s_cmp_lt_i32 s29, 21
    s_cbranch_scc1 L_l2
L_lend:
    s_endpgm
L_fchk:
    s_mov_b32 s59, 0x10101010
L_fc:
    s_mov_b32 s33, 0x40000
    s_waitcnt lgkmcnt(0)
    s_and_b64 s[42:43], s[80:81], s[82:83]
    s_and_b64 s[42:43], s[42:43], s[84:85]
    s_and_b64 s[42:43], s[42:43], s[86:87]
    s_and_b32 s42, s42, s43
    s_and_b32 s42, s42, s59
    s_cmp_lg_u32 s42, s59
    s_cbranch_scc1 L_fp
L_fok:
    s_cmp_eq_u32 s18, 1
    s_cselect_b64 s[80:81], s[82:83], s[80:81]
    s_cmp_eq_u32 s18, 2
    s_cselect_b64 s[80:81], s[84:85], s[80:81]
    s_cmp_eq_u32 s18, 3
    s_cselect_b64 s[80:81], s[86:87], s[80:81]
    s_getreg_b32 s42, hwreg(HW_REG_XCC_ID, 0, 4)
    s_or_b32 s42, s42, 16
    s_mul_i32 s42, s42, 0x01010101
    s_mov_b32 s43, s42
    s_and_b32 s80, s80, 0xdfdfdfdf
    s_and_b32 s81, s81, 0xdfdfdfdf
    s_cmp_eq_u64 s[42:43], s[80:81]
    s_cselect_b32 s42, 1, 0
    v_mov_b32 v38, 32
    v_mov_b32 v39, s42
    ds_write_b32 v38, v39
    s_branch L_fret
L_fp:
    v_and_b32 v38, 7, v0
    v_lshl_add_u32 v38, v38, 2, s21
L_fp1:
    global_load_dword v39, v38, s[38:39] sc1
    s_waitcnt vmcnt(0)
    v_readlane_b32 s80, v39, 0
    v_readlane_b32 s81, v39, 1
    v_readlane_b32 s82, v39, 2
    v_readlane_b32 s83, v39, 3
    v_readlane_b32 s84, v39, 4
    v_readlane_b32 s85, v39, 5
    v_readlane_b32 s86, v39, 6
    v_readlane_b32 s87, v39, 7
    v_and_b32 v39, s59, v39
    v_cmp_ne_u32 vcc, s59, v39
    s_cbranch_vccz L_fok
    s_sub_u32 s33, s33, 1
    s_cbranch_scc1 L_fok
    s_sleep 8
    s_branch L_fp1
L_compute:
    s_lshl_b32 s3, s16, 8
    s_add_u32 s3, s3, 256
    v_add_u32 v16, s3, v13
    ds_write_b32 v16, v12
    v_lshrrev_b32 v10, 5, v0
    v_bfe_u32 v11, v0, 2, 2
    v_bfe_u32 v12, v0, 4, 1
    v_and_b32 v13, 1, v0
    v_bfe_u32 v14, v0, 1, 1
    v_lshl_add_u32 v15, v10, 3, v11
    v_lshlrev_b32 v15, 8, v15
    v_lshl_add_u32 v15, v11, 6, v15
    v_lshl_add_u32 v15, v12, 5, v15
    v_lshl_add_u32 v15, v13, 4, v15
    v_lshl_add_u32 v2, v14, 3, v15
    v_add_u32 v2, 2048, v2
    v_xor_b32 v3, 64, v2
    v_xor_b32 v4, 128, v2
    v_xor_b32 v5, 192, v2
    v_and_b32 v11, 31, v0
    v_bfe_u32 v12, v0, 1, 3
    v_xor_b32 v12, v12, v10
    v_lshlrev_b32 v12, 4, v12
    v_lshl_add_u32 v12, v11, 7, v12
    s_lshl_b32 s3, s16, 12
    s_add_u32 s3, s3, 18432
    v_add_u32 v6, s3, v12
    v_xor_b32 v7, 32, v6
    v_xor_b32 v8, 64, v6
    v_xor_b32 v9, 96, v6
    v_lshlrev_b32 v1, 4, v0
    v_mov_b32 v64, 0
    v_mov_b32 v65, 0
    v_mov_b32 v66, 0
    v_mov_b32 v67, 0
    v_mov_b32 v68, 0
    v_mov_b32 v69, 0
    v_mov_b32 v70, 0
    v_mov_b32 v71, 0
    v_mov_b32 v72, 0
    v_mov_b32 v73, 0
    v_mov_b32 v74, 0
    v_mov_b32 v75, 0
    v_mov_b32 v76, 0
    v_mov_b32 v77, 0
    v_mov_b32 v78, 0
    v_mov_b32 v79, 0
    v_mov_b32 v80, 0
    v_mov_b32 v81, 0
    v_mov_b32 v82, 0
    v_mov_b32 v83, 0
    v_mov_b32 v84, 0
    v_mov_b32 v85, 0
    v_mov_b32 v86, 0
    v_mov_b32 v87, 0
    v_mov_b32 v88, 0
    v_mov_b32 v89, 0
    v_mov_b32 v90, 0
    v_mov_b32 v91, 0
    v_mov_b32 v92, 0
    v_mov_b32 v93, 0
    v_mov_b32 v94, 0
    v_mov_b32 v95, 0
    v_mov_b32 v96, 0
    v_mov_b32 v97, 0
    v_mov_b32 v98, 0
    v_mov_b32 v99, 0
    v_mov_b32 v100, 0
    v_mov_b32 v101, 0
    v_mov_b32 v102, 0
    v_mov_b32 v103, 0
    v_mov_b32 v104, 0
    v_mov_b32 v105, 0
    v_mov_b32 v106, 0
    v_mov_b32 v107, 0
    v_mov_b32 v108, 0
    v_mov_b32 v109, 0
    v_mov_b32 v110, 0
    v_mov_b32 v111, 0
    v_mov_b32 v112, 0
    v_mov_b32 v113, 0
    v_mov_b32 v114, 0
    v_mov_b32 v115, 0
    v_mov_b32 v116, 0
    v_mov_b32 v117, 0
    v_mov_b32 v118, 0
    v_mov_b32 v119, 0
    v_mov_b32 v120, 0
    v_mov_b32 v121, 0
    v_mov_b32 v122, 0
    v_mov_b32 v123, 0
    v_mov_b32 v124, 0
    v_mov_b32 v125, 0
    v_mov_b32 v126, 0
    v_mov_b32 v127, 0
    s_lshl_b32 s23, s19, 2
    s_add_u32 s23, s23, s16
    s_waitcnt lgkmcnt(0)
    s_barrier
    s_lshl_b32 s25, s18, 3
    s_add_u32 s25, s25, s21
    s_lshl_b32 s24, s25, 16
    s_lshl_b32 s3, s16, 13
    s_add_u32 s24, s24, s3
    s_add_u32 s25, s25, s20
    s_lshl_b32 s34, s20, 16
    s_add_u32 s34, s34, s24
    v_mov_b32 v13, v16
    v_mov_b32 v12, 0
    v_mov_b32 v11, 0
    s_and_b32 s45, s45, 0xffff
    s_mov_b32 s12, s36
    s_and_b32 s13, s37, 0xffff
    s_mov_b32 s14, 0x200000
    s_mov_b32 s15, 0x20000
    s_mov_b32 s26, 0
    s_mov_b32 s28, 32768
    s_lshl_b32 s3, s16, 12
    s_add_u32 s3, s3, 131072
    v_lshrrev_b32 v15, 5, v0
    v_lshlrev_b32 v15, 10, v15
    v_sub_u32 v15, s3, v15
    v_mov_b32 v10, 0
    v_add_u32 v56, 114688, v6
    v_add_u32 v60, v2, v15
    v_add_u32 v57, 114688, v7
    v_add_u32 v61, v3, v15
    v_add_u32 v58, 114688, v8
    v_add_u32 v62, v4, v15
    v_add_u32 v59, 114688, v9
    v_add_u32 v63, v5, v15
    s_add_u32 s35, s19, s20
    s_add_u32 s35, s35, 3
    s_and_b32 s35, s35, 3
    s_mov_b32 s31, 0
L_rc0:
    s_waitcnt lgkmcnt(0)
    v_cmp_le_u32 vcc, v10, v12
    s_cbranch_vccnz L_rw0
L_rx0:
    ds_read_b128 v[48:51], v6
    ds_read_b64_tr_b16 v[16:17], v2 offset:0
    ds_read_b64_tr_b16 v[18:19], v2 offset:1024
    ds_read_b64_tr_b16 v[20:21], v3 offset:0
    ds_read_b64_tr_b16 v[22:23], v3 offset:1024
    ds_read_b64_tr_b16 v[24:25], v4 offset:0
    ds_read_b64_tr_b16 v[26:27], v4 offset:1024
    ds_read_b64_tr_b16 v[28:29], v5 offset:0
    ds_read_b64_tr_b16 v[30:31], v5 offset:1024
    s_mov_b32 s29, 15
L_p1:
    s_waitcnt lgkmcnt(6)
    v_mfma_f32_32x32x16_bf16 v[64:79], v[16:19], v[48:51], v[64:79]
    ds_read_b128 v[52:55], v7
    ds_read_b64_tr_b16 v[32:33], v2 offset:4096
    ds_read_b64_tr_b16 v[34:35], v2 offset:5120
    s_waitcnt lgkmcnt(7)
    v_mfma_f32_32x32x16_bf16 v[80:95], v[20:23], v[48:51], v[80:95]
    ds_read_b64_tr_b16 v[36:37], v3 offset:4096
    ds_read_b64_tr_b16 v[38:39], v3 offset:5120
    s_cmp_eq_u32 s26, s35
    s_cbranch_scc1 L_pca
L_pra:
    s_waitcnt lgkmcnt(7)
    v_mfma_f32_32x32x16_bf16 v[96:111], v[24:27], v[48:51], v[96:111]
    ds_read_b64_tr_b16 v[40:41], v4 offset:4096
    ds_read_b64_tr_b16 v[42:43], v4 offset:5120
    s_waitcnt lgkmcnt(7)
    v_mfma_f32_32x32x16_bf16 v[112:127], v[28:31], v[48:51], v[112:127]
    ds_read_b64_tr_b16 v[44:45], v5 offset:4096
    ds_read_b64_tr_b16 v[46:47], v5 offset:5120
    s_waitcnt lgkmcnt(6)
    v_mfma_f32_32x32x16_bf16 v[64:79], v[32:35], v[52:55], v[64:79]
    ds_read_b128 v[48:51], v8
    ds_read_b64_tr_b16 v[16:17], v2 offset:8192
    ds_read_b64_tr_b16 v[18:19], v2 offset:9216
    s_waitcnt lgkmcnt(7)
    v_mfma_f32_32x32x16_bf16 v[80:95], v[36:39], v[52:55], v[80:95]
    ds_read_b64_tr_b16 v[20:21], v3 offset:8192
    ds_read_b64_tr_b16 v[22:23], v3 offset:9216
    s_waitcnt lgkmcnt(7)
    v_mfma_f32_32x32x16_bf16 v[96:111], v[40:43], v[52:55], v[96:111]
    ds_read_b64_tr_b16 v[24:25], v4 offset:8192
    ds_read_b64_tr_b16 v[26:27], v4 offset:9216
    s_waitcnt lgkmcnt(7)
    v_mfma_f32_32x32x16_bf16 v[112:127], v[44:47], v[52:55], v[112:127]
    ds_read_b64_tr_b16 v[28:29], v5 offset:8192
    ds_read_b64_tr_b16 v[30:31], v5 offset:9216
    s_waitcnt lgkmcnt(6)
    v_mfma_f32_32x32x16_bf16 v[64:79], v[16:19], v[48:51], v[64:79]
    ds_read_b128 v[52:55], v9
    ds_read_b64_tr_b16 v[32:33], v2 offset:12288
    ds_read_b64_tr_b16 v[34:35], v2 offset:13312
    s_add_u32 s26, s26, 1
    s_cmp_eq_u32 s26, 4
    s_cselect_b32 s26, 0, s26
    s_cselect_b32 s27, 4294868992, s28
    v_add_u32 v12, 1, v12
    v_lshlrev_b32 v11, 2, s26
    s_waitcnt lgkmcnt(7)
    v_mfma_f32_32x32x16_bf16 v[80:95], v[20:23], v[48:51], v[80:95]
    ds_read_b64_tr_b16 v[36:37], v3 offset:12288
    ds_read_b64_tr_b16 v[38:39], v3 offset:13312
    s_waitcnt lgkmcnt(7)
    v_mfma_f32_32x32x16_bf16 v[96:111], v[24:27], v[48:51], v[96:111]
    ds_read_b64_tr_b16 v[40:41], v4 offset:12288
    ds_read_b64_tr_b16 v[42:43], v4 offset:13312
    s_waitcnt lgkmcnt(7)
    v_mfma_f32_32x32x16_bf16 v[112:127], v[28:31], v[48:51], v[112:127]
    ds_read_b64_tr_b16 v[44:45], v5 offset:12288
    ds_read_b64_tr_b16 v[46:47], v5 offset:13312
    ds_write_b32 v13, v12
    ds_read_b32 v10, v11
    s_waitcnt lgkmcnt(8)
    v_mfma_f32_32x32x16_bf16 v[64:79], v[32:35], v[52:55], v[64:79]
    v_add_u32 v2, s27, v2
    v_add_u32 v3, s27, v3
    v_add_u32 v4, s27, v4
    v_add_u32 v5, s27, v5
    s_waitcnt lgkmcnt(6)
    v_mfma_f32_32x32x16_bf16 v[80:95], v[36:39], v[52:55], v[80:95]
    v_add_u32 v6, s27, v6
    v_add_u32 v7, s27, v7
    v_add_u32 v8, s27, v8
    v_add_u32 v9, s27, v9
L_rc1:
    s_waitcnt lgkmcnt(0)
    v_cmp_le_u32 vcc, v10, v12
    s_cbranch_vccnz L_rw1
L_rx1:
    ds_read_b128 v[48:51], v6
    ds_read_b64_tr_b16 v[16:17], v2 offset:0
    ds_read_b64_tr_b16 v[18:19], v2 offset:1024
    v_mfma_f32_32x32x16_bf16 v[96:111], v[40:43], v[52:55], v[96:111]
    ds_read_b64_tr_b16 v[20:21], v3 offset:0
    ds_read_b64_tr_b16 v[22:23], v3 offset:1024
    ds_read_b64_tr_b16 v[24:25], v4 offset:0
    ds_read_b64_tr_b16 v[26:27], v4 offset:1024
    v_mfma_f32_32x32x16_bf16 v[112:127], v[44:47], v[52:55], v[112:127]
    ds_read_b64_tr_b16 v[28:29], v5 offset:0
    ds_read_b64_tr_b16 v[30:31], v5 offset:1024
    s_sub_u32 s29, s29, 1
    s_cmp_lg_u32 s29, 0
    s_cbranch_scc1 L_p1
    s_waitcnt lgkmcnt(6)
    v_mfma_f32_32x32x16_bf16 v[64:79], v[16:19], v[48:51], v[64:79]
    ds_read_b128 v[52:55], v7
    ds_read_b64_tr_b16 v[32:33], v2 offset:4096
    ds_read_b64_tr_b16 v[34:35], v2 offset:5120
    s_waitcnt lgkmcnt(7)
    v_mfma_f32_32x32x16_bf16 v[80:95], v[20:23], v[48:51], v[80:95]
    ds_read_b64_tr_b16 v[36:37], v3 offset:4096
    ds_read_b64_tr_b16 v[38:39], v3 offset:5120
    s_cmp_eq_u32 s26, s35
    s_cbranch_scc1 L_pcb
L_prb:
    s_waitcnt lgkmcnt(7)
    v_mfma_f32_32x32x16_bf16 v[96:111], v[24:27], v[48:51], v[96:111]
    ds_read_b64_tr_b16 v[40:41], v4 offset:4096
    ds_read_b64_tr_b16 v[42:43], v4 offset:5120
    v_mov_b32 v15, 32
    ds_read_b32 v15, v15
    s_waitcnt lgkmcnt(7)
    v_mfma_f32_32x32x16_bf16 v[112:127], v[28:31], v[48:51], v[112:127]
    ds_read_b64_tr_b16 v[44:45], v5 offset:4096
    ds_read_b64_tr_b16 v[46:47], v5 offset:5120
    s_waitcnt lgkmcnt(6)
    v_mfma_f32_32x32x16_bf16 v[64:79], v[32:35], v[52:55], v[64:79]
    ds_read_b128 v[48:51], v8
    ds_read_b64_tr_b16 v[16:17], v2 offset:8192
    ds_read_b64_tr_b16 v[18:19], v2 offset:9216
    s_waitcnt lgkmcnt(7)
    v_mfma_f32_32x32x16_bf16 v[80:95], v[36:39], v[52:55], v[80:95]
    ds_read_b64_tr_b16 v[20:21], v3 offset:8192
    ds_read_b64_tr_b16 v[22:23], v3 offset:9216
    s_waitcnt lgkmcnt(7)
    v_mfma_f32_32x32x16_bf16 v[96:111], v[40:43], v[52:55], v[96:111]
    ds_read_b64_tr_b16 v[24:25], v4 offset:8192
    ds_read_b64_tr_b16 v[26:27], v4 offset:9216
    s_waitcnt lgkmcnt(7)
    v_mfma_f32_32x32x16_bf16 v[112:127], v[44:47], v[52:55], v[112:127]
    ds_read_b64_tr_b16 v[28:29], v5 offset:8192
    ds_read_b64_tr_b16 v[30:31], v5 offset:9216
    s_waitcnt lgkmcnt(6)
    v_mfma_f32_32x32x16_bf16 v[64:79], v[16:19], v[48:51], v[64:79]
    ds_read_b128 v[52:55], v9
    ds_read_b64_tr_b16 v[32:33], v2 offset:12288
    ds_read_b64_tr_b16 v[34:35], v2 offset:13312
    s_add_u32 s26, s26, 1
    s_cmp_eq_u32 s26, 4
    s_cselect_b32 s26, 0, s26
    s_cselect_b32 s27, 4294868992, s28
    v_add_u32 v12, 1, v12
    v_lshlrev_b32 v11, 2, s26
    s_waitcnt lgkmcnt(7)
    v_mfma_f32_32x32x16_bf16 v[80:95], v[20:23], v[48:51], v[80:95]
    ds_read_b64_tr_b16 v[36:37], v3 offset:12288
    ds_read_b64_tr_b16 v[38:39], v3 offset:13312
    s_waitcnt lgkmcnt(7)
    v_mfma_f32_32x32x16_bf16 v[96:111], v[24:27], v[48:51], v[96:111]
    ds_read_b64_tr_b16 v[40:41], v4 offset:12288
    ds_read_b64_tr_b16 v[42:43], v4 offset:13312
    s_waitcnt lgkmcnt(7)
    v_mfma_f32_32x32x16_bf16 v[112:127], v[28:31], v[48:51], v[112:127]
    ds_read_b64_tr_b16 v[44:45], v5 offset:12288
    ds_read_b64_tr_b16 v[46:47], v5 offset:13312
    ds_write_b32 v13, v12
    ds_read_b32 v10, v11
    s_waitcnt lgkmcnt(8)
    v_mfma_f32_32x32x16_bf16 v[64:79], v[32:35], v[52:55], v[64:79]
    v_add_u32 v2, s27, v2
    v_add_u32 v3, s27, v3
    v_add_u32 v4, s27, v4
    v_add_u32 v5, s27, v5
    s_waitcnt lgkmcnt(6)
    v_mfma_f32_32x32x16_bf16 v[80:95], v[36:39], v[52:55], v[80:95]
    v_add_u32 v6, s27, v6
    v_add_u32 v7, s27, v7
    v_add_u32 v8, s27, v8
    v_add_u32 v9, s27, v9
    s_waitcnt lgkmcnt(4)
    v_mfma_f32_32x32x16_bf16 v[96:111], v[40:43], v[52:55], v[96:111]
    s_waitcnt lgkmcnt(2)
    v_mfma_f32_32x32x16_bf16 v[112:127], v[44:47], v[52:55], v[112:127]
    v_cvt_pk_bf16_f32 v192, v64, v65
    v_cvt_pk_bf16_f32 v193, v66, v67
    v_cvt_pk_bf16_f32 v194, v68, v69
    v_cvt_pk_bf16_f32 v195, v70, v71
    v_cvt_pk_bf16_f32 v196, v72, v73
    v_cvt_pk_bf16_f32 v197, v74, v75
    v_cvt_pk_bf16_f32 v198, v76, v77
    v_cvt_pk_bf16_f32 v199, v78, v79
    v_cvt_pk_bf16_f32 v200, v80, v81
    v_cvt_pk_bf16_f32 v201, v82, v83
    v_cvt_pk_bf16_f32 v202, v84, v85
    v_cvt_pk_bf16_f32 v203, v86, v87
    v_cvt_pk_bf16_f32 v204, v88, v89
    v_cvt_pk_bf16_f32 v205, v90, v91
    v_cvt_pk_bf16_f32 v206, v92, v93
    v_cvt_pk_bf16_f32 v207, v94, v95
    v_mfma_f32_32x32x16_bf16 v[160:175], v[128:131], v[192:195], 0
    v_cvt_pk_bf16_f32 v208, v96, v97
    v_cvt_pk_bf16_f32 v209, v98, v99
    v_cvt_pk_bf16_f32 v210, v100, v101
    v_cvt_pk_bf16_f32 v211, v102, v103
    v_mfma_f32_32x32x16_bf16 v[160:175], v[132:135], v[196:199], v[160:175]
    v_cvt_pk_bf16_f32 v212, v104, v105
    v_cvt_pk_bf16_f32 v213, v106, v107
    v_cvt_pk_bf16_f32 v214, v108, v109
    v_cvt_pk_bf16_f32 v215, v110, v111
    v_mfma_f32_32x32x16_bf16 v[160:175], v[136:139], v[200:203], v[160:175]
    v_cvt_pk_bf16_f32 v216, v112, v113
    v_cvt_pk_bf16_f32 v217, v114, v115
    v_cvt_pk_bf16_f32 v218, v116, v117
    v_cvt_pk_bf16_f32 v219, v118, v119
    v_mfma_f32_32x32x16_bf16 v[160:175], v[140:143], v[204:207], v[160:175]
    v_cvt_pk_bf16_f32 v220, v120, v121
    v_cvt_pk_bf16_f32 v221, v122, v123
    v_cvt_pk_bf16_f32 v222, v124, v125
    v_cvt_pk_bf16_f32 v223, v126, v127
    v_mfma_f32_32x32x16_bf16 v[160:175], v[144:147], v[208:211], v[160:175]
    v_mfma_f32_32x32x16_bf16 v[160:175], v[148:151], v[212:215], v[160:175]
    v_mfma_f32_32x32x16_bf16 v[160:175], v[152:155], v[216:219], v[160:175]
    v_mfma_f32_32x32x16_bf16 v[160:175], v[156:159], v[220:223], v[160:175]
    s_mov_b32 s30, 0x3e0293ee
    s_add_u32 s3, s34, 4096
    v_readfirstlane_b32 s31, v15
    s_nop 7
    s_cmp_eq_u32 s31, 1
    v_max3_f32 v14, v160, v161, v162
    v_max3_f32 v14, v14, v163, v164
    v_max3_f32 v14, v14, v165, v166
    v_max3_f32 v14, v14, v167, v168
    v_max3_f32 v14, v14, v169, v170
    v_max3_f32 v14, v14, v171, v172
    v_max3_f32 v14, v14, v173, v174
    v_max_f32 v14, v14, v175
    v_mov_b32 v15, v14
    s_nop 1
    v_permlane32_swap_b32 v14, v15
    s_nop 1
    v_max_f32 v14, v14, v15
    v_mul_f32 v14, s30, v14
    v_fma_f32 v160, v160, s30, -v14
    v_fma_f32 v161, v161, s30, -v14
    v_fma_f32 v162, v162, s30, -v14
    v_fma_f32 v163, v163, s30, -v14
    v_fma_f32 v164, v164, s30, -v14
    v_fma_f32 v165, v165, s30, -v14
    v_fma_f32 v166, v166, s30, -v14
    v_fma_f32 v167, v167, s30, -v14
    v_fma_f32 v168, v168, s30, -v14
    v_fma_f32 v169, v169, s30, -v14
    v_fma_f32 v170, v170, s30, -v14
    v_fma_f32 v171, v171, s30, -v14
    v_fma_f32 v172, v172, s30, -v14
    v_fma_f32 v173, v173, s30, -v14
    v_fma_f32 v174, v174, s30, -v14
    v_fma_f32 v175, v175, s30, -v14
    v_exp_f32 v160, v160
    v_exp_f32 v161, v161
    v_exp_f32 v162, v162
    v_exp_f32 v163, v163
    v_exp_f32 v164, v164
    v_exp_f32 v165, v165
    v_exp_f32 v166, v166
    v_exp_f32 v167, v167
    v_exp_f32 v168, v168
    v_exp_f32 v169, v169
    v_exp_f32 v170, v170
    v_exp_f32 v171, v171
    v_exp_f32 v172, v172
    v_exp_f32 v173, v173
    v_exp_f32 v174, v174
    v_exp_f32 v175, v175
    s_nop 0
    v_add_f32 v14, v160, v161
    v_add_f32 v15, v162, v163
    v_add_f32 v14, v14, v164
    v_add_f32 v15, v15, v165
    v_add_f32 v14, v14, v166
    v_add_f32 v15, v15, v167
    v_add_f32 v14, v14, v168
    v_add_f32 v15, v15, v169
    v_add_f32 v14, v14, v170
    v_add_f32 v15, v15, v171
    v_add_f32 v14, v14, v172
    v_add_f32 v15, v15, v173
    v_add_f32 v14, v14, v174
    v_add_f32 v15, v15, v175
    v_add_f32 v14, v14, v15
    v_mov_b32 v15, v14
    s_nop 1
    v_permlane32_swap_b32 v14, v15
    s_nop 1
    v_add_f32 v14, v14, v15
    v_rcp_f32 v14, v14
    s_nop 0
    v_mul_f32 v160, v160, v14
    v_mul_f32 v161, v161, v14
    v_mul_f32 v162, v162, v14
    v_mul_f32 v163, v163, v14
    v_mul_f32 v164, v164, v14
    v_mul_f32 v165, v165, v14
    v_mul_f32 v166, v166, v14
    v_mul_f32 v167, v167, v14
    v_mul_f32 v168, v168, v14
    v_mul_f32 v169, v169, v14
    v_mul_f32 v170, v170, v14
    v_mul_f32 v171, v171, v14
    v_mul_f32 v172, v172, v14
    v_mul_f32 v173, v173, v14
    v_mul_f32 v174, v174, v14
    v_mul_f32 v175, v175, v14
    v_cvt_pk_bf16_f32 v56, v160, v161
    v_cvt_pk_bf16_f32 v57, v162, v163
    v_cvt_pk_bf16_f32 v58, v164, v165
    v_cvt_pk_bf16_f32 v59, v166, v167
    v_cvt_pk_bf16_f32 v60, v168, v169
    v_cvt_pk_bf16_f32 v61, v170, v171
    v_cvt_pk_bf16_f32 v62, v172, v173
    v_cvt_pk_bf16_f32 v63, v174, v175
    s_nop 1
    v_mfma_f32_32x32x16_bf16 v[64:79], v[224:227], v[56:59], 0
    v_mfma_f32_32x32x16_bf16 v[64:79], v[228:231], v[60:63], v[64:79]
    v_mfma_f32_32x32x16_bf16 v[80:95], v[232:235], v[56:59], 0
    v_mfma_f32_32x32x16_bf16 v[80:95], v[236:239], v[60:63], v[80:95]
    v_mfma_f32_32x32x16_bf16 v[96:111], v[240:243], v[56:59], 0
    v_mfma_f32_32x32x16_bf16 v[96:111], v[244:247], v[60:63], v[96:111]
    v_cvt_pk_bf16_f32 v128, v64, v65
    v_cvt_pk_bf16_f32 v129, v66, v67
    v_cvt_pk_bf16_f32 v130, v68, v69
    v_cvt_pk_bf16_f32 v131, v70, v71
    v_cvt_pk_bf16_f32 v132, v72, v73
    v_cvt_pk_bf16_f32 v133, v74, v75
    v_cvt_pk_bf16_f32 v134, v76, v77
    v_cvt_pk_bf16_f32 v135, v78, v79
    s_cbranch_scc0 L_os0
    buffer_store_dwordx4 v[128:131], v1, s[44:47], s34 offen offset:0
    buffer_store_dwordx4 v[132:135], v1, s[44:47], s34 offen offset:1024
L_or0:
    v_mfma_f32_32x32x16_bf16 v[112:127], v[248:251], v[56:59], 0
    v_mfma_f32_32x32x16_bf16 v[112:127], v[252:255], v[60:63], v[112:127]
    v_cvt_pk_bf16_f32 v136, v80, v81
    v_cvt_pk_bf16_f32 v137, v82, v83
    v_cvt_pk_bf16_f32 v138, v84, v85
    v_cvt_pk_bf16_f32 v139, v86, v87
    v_cvt_pk_bf16_f32 v140, v88, v89
    v_cvt_pk_bf16_f32 v141, v90, v91
    v_cvt_pk_bf16_f32 v142, v92, v93
    v_cvt_pk_bf16_f32 v143, v94, v95
    s_cbranch_scc0 L_os1
    buffer_store_dwordx4 v[136:139], v1, s[44:47], s34 offen offset:2048
    buffer_store_dwordx4 v[140:143], v1, s[44:47], s34 offen offset:3072
L_or1:
    v_cvt_pk_bf16_f32 v144, v96, v97
    v_cvt_pk_bf16_f32 v145, v98, v99
    v_cvt_pk_bf16_f32 v146, v100, v101
    v_cvt_pk_bf16_f32 v147, v102, v103
    v_cvt_pk_bf16_f32 v148, v104, v105
    v_cvt_pk_bf16_f32 v149, v106, v107
    v_cvt_pk_bf16_f32 v150, v108, v109
    v_cvt_pk_bf16_f32 v151, v110, v111
    s_cbranch_scc0 L_os2
    buffer_store_dwordx4 v[144:147], v1, s[44:47], s3 offen offset:0
    buffer_store_dwordx4 v[148:151], v1, s[44:47], s3 offen offset:1024
L_or2:
    v_cvt_pk_bf16_f32 v152, v112, v113
    v_cvt_pk_bf16_f32 v153, v114, v115
    v_cvt_pk_bf16_f32 v154, v116, v117
    v_cvt_pk_bf16_f32 v155, v118, v119
    v_cvt_pk_bf16_f32 v156, v120, v121
    v_cvt_pk_bf16_f32 v157, v122, v123
    v_cvt_pk_bf16_f32 v158, v124, v125
    v_cvt_pk_bf16_f32 v159, v126, v127
    s_cbranch_scc0 L_os3
    buffer_store_dwordx4 v[152:155], v1, s[44:47], s3 offen offset:2048
    buffer_store_dwordx4 v[156:159], v1, s[44:47], s3 offen offset:3072
L_or3:
L_rc2:
    s_waitcnt lgkmcnt(0)
    v_cmp_le_u32 vcc, v10, v12
    s_cbranch_vccnz L_rw2
L_rx2:
    ds_read_b64_tr_b16 v[16:17], v2 offset:0
    ds_read_b64_tr_b16 v[18:19], v2 offset:1024
    ds_read_b64_tr_b16 v[20:21], v3 offset:0
    ds_read_b64_tr_b16 v[22:23], v3 offset:1024
    ds_read_b64_tr_b16 v[24:25], v4 offset:0
    ds_read_b64_tr_b16 v[26:27], v4 offset:1024
    ds_read_b64_tr_b16 v[28:29], v5 offset:0
    ds_read_b64_tr_b16 v[30:31], v5 offset:1024
    s_mov_b32 s33, 0x40000
    s_lshl_b32 s3, s16, 13
    s_sub_u32 s56, s34, s3
    s_add_u32 s56, s56, 57088
    s_sub_u32 s57, s24, s3
    s_lshl_b32 s3, s16, 8
    s_add_u32 s57, s57, s3
    s_add_u32 s57, s57, 57344
    v_and_b32 v9, 7, v0
    v_lshlrev_b32 v9, 16, v9
    v_mov_b32 v7, 0
    s_waitcnt lgkmcnt(6)
    v_mfma_f32_32x32x16_bf16 v[64:79], v[16:19], v[128:131], 0
    ds_read_b64_tr_b16 v[32:33], v2 offset:4096
    ds_read_b64_tr_b16 v[34:35], v2 offset:5120
    s_waitcnt lgkmcnt(6)
    v_mfma_f32_32x32x16_bf16 v[80:95], v[20:23], v[128:131], 0
    ds_read_b64_tr_b16 v[36:37], v3 offset:4096
    ds_read_b64_tr_b16 v[38:39], v3 offset:5120
    s_waitcnt lgkmcnt(6)
    v_mfma_f32_32x32x16_bf16 v[96:111], v[24:27], v[128:131], 0
    ds_read_b64_tr_b16 v[40:41], v4 offset:4096
    ds_read_b64_tr_b16 v[42:43], v4 offset:5120
    s_waitcnt lgkmcnt(6)
    v_mfma_f32_32x32x16_bf16 v[112:127], v[28:31], v[128:131], 0
    ds_read_b64_tr_b16 v[44:45], v5 offset:4096
    ds_read_b64_tr_b16 v[46:47], v5 offset:5120
    s_waitcnt lgkmcnt(6)
    v_mfma_f32_32x32x16_bf16 v[64:79], v[32:35], v[132:135], v[64:79]
    ds_read_b64_tr_b16 v[16:17], v2 offset:8192
    ds_read_b64_tr_b16 v[18:19], v2 offset:9216
    s_cmp_eq_u32 s31, 1
    s_waitcnt vmcnt(0)
    s_cbranch_scc0 L_fs
    buffer_store_dword v7, v13, s[44:47], s56 offen
L_fe:
    s_waitcnt lgkmcnt(6)
    v_mfma_f32_32x32x16_bf16 v[80:95], v[36:39], v[132:135], v[80:95]
    ds_read_b64_tr_b16 v[20:21], v3 offset:8192
    ds_read_b64_tr_b16 v[22:23], v3 offset:9216
    s_waitcnt lgkmcnt(6)
    v_mfma_f32_32x32x16_bf16 v[96:111], v[40:43], v[132:135], v[96:111]
    ds_read_b64_tr_b16 v[24:25], v4 offset:8192
    ds_read_b64_tr_b16 v[26:27], v4 offset:9216
    s_waitcnt lgkmcnt(6)
    v_mfma_f32_32x32x16_bf16 v[112:127], v[44:47], v[132:135], v[112:127]
    ds_read_b64_tr_b16 v[28:29], v5 offset:8192
    ds_read_b64_tr_b16 v[30:31], v5 offset:9216
    buffer_load_dword v8, v9, s[44:47], s57 offen sc1
    s_waitcnt lgkmcnt(6)
    v_mfma_f32_32x32x16_bf16 v[64:79], v[16:19], v[136:139], v[64:79]
    ds_read_b64_tr_b16 v[32:33], v2 offset:12288
    ds_read_b64_tr_b16 v[34:35], v2 offset:13312
    s_waitcnt lgkmcnt(6)
    v_mfma_f32_32x32x16_bf16 v[80:95], v[20:23], v[136:139], v[80:95]
    ds_read_b64_tr_b16 v[36:37], v3 offset:12288
    ds_read_b64_tr_b16 v[38:39], v3 offset:13312
    s_waitcnt lgkmcnt(6)
    v_mfma_f32_32x32x16_bf16 v[96:111], v[24:27], v[136:139], v[96:111]
    ds_read_b64_tr_b16 v[40:41], v4 offset:12288
    ds_read_b64_tr_b16 v[42:43], v4 offset:13312
    s_waitcnt lgkmcnt(6)
    v_mfma_f32_32x32x16_bf16 v[112:127], v[28:31], v[136:139], v[112:127]
    ds_read_b64_tr_b16 v[44:45], v5 offset:12288
    ds_read_b64_tr_b16 v[46:47], v5 offset:13312
    s_waitcnt lgkmcnt(6)
    v_mfma_f32_32x32x16_bf16 v[64:79], v[32:35], v[140:143], v[64:79]
    ds_read_b64_tr_b16 v[16:17], v2 offset:16384
    ds_read_b64_tr_b16 v[18:19], v2 offset:17408
    s_waitcnt lgkmcnt(6)
    v_mfma_f32_32x32x16_bf16 v[80:95], v[36:39], v[140:143], v[80:95]
    ds_read_b64_tr_b16 v[20:21], v3 offset:16384
    ds_read_b64_tr_b16 v[22:23], v3 offset:17408
    s_waitcnt lgkmcnt(6)
    v_mfma_f32_32x32x16_bf16 v[96:111], v[40:43], v[140:143], v[96:111]
    ds_read_b64_tr_b16 v[24:25], v4 offset:16384
    ds_read_b64_tr_b16 v[26:27], v4 offset:17408
    s_waitcnt lgkmcnt(6)
    v_mfma_f32_32x32x16_bf16 v[112:127], v[44:47], v[140:143], v[112:127]
    ds_read_b64_tr_b16 v[28:29], v5 offset:16384
    ds_read_b64_tr_b16 v[30:31], v5 offset:17408
    s_waitcnt lgkmcnt(6)
    v_mfma_f32_32x32x16_bf16 v[64:79], v[16:19], v[144:147], v[64:79]
    ds_read_b64_tr_b16 v[32:33], v2 offset:20480
    ds_read_b64_tr_b16 v[34:35], v2 offset:21504
    s_waitcnt vmcnt(0)
    s_waitcnt lgkmcnt(6)
    v_mfma_f32_32x32x16_bf16 v[80:95], v[20:23], v[144:147], v[80:95]
    ds_read_b64_tr_b16 v[36:37], v3 offset:20480
    ds_read_b64_tr_b16 v[38:39], v3 offset:21504
    s_lshr_b32 s101, s101, 4
    s_and_b32 s6, s101, 7
    s_xor_b32 s6, s6, s20
    v_cmp_eq_u32 vcc, -1, v8
    s_nop 0
    s_bitcmp1_b32 vcc_lo, s6
    s_cbranch_scc1 L_fr1
L_fo1:
    s_lshl_b32 s6, s6, 16
    s_add_u32 s6, s6, s24
    s_add_u32 s7, s6, 4096
    buffer_load_dwordx4 v[160:163], v1, s[44:47], s6 offen offset:0 sc1
    buffer_load_dwordx4 v[164:167], v1, s[44:47], s6 offen offset:1024 sc1
    buffer_load_dwordx4 v[168:171], v1, s[44:47], s6 offen offset:2048 sc1
    buffer_load_dwordx4 v[172:175], v1, s[44:47], s6 offen offset:3072 sc1
    buffer_load_dwordx4 v[176:179], v1, s[44:47], s7 offen offset:0 sc1
    buffer_load_dwordx4 v[180:183], v1, s[44:47], s7 offen offset:1024 sc1
    buffer_load_dwordx4 v[184:187], v1, s[44:47], s7 offen offset:2048 sc1
    buffer_load_dwordx4 v[188:191], v1, s[44:47], s7 offen offset:3072 sc1
    s_waitcnt lgkmcnt(6)
    v_mfma_f32_32x32x16_bf16 v[96:111], v[24:27], v[144:147], v[96:111]
    ds_read_b64_tr_b16 v[40:41], v4 offset:20480
    ds_read_b64_tr_b16 v[42:43], v4 offset:21504
    s_waitcnt lgkmcnt(6)
    v_mfma_f32_32x32x16_bf16 v[112:127], v[28:31], v[144:147], v[112:127]
    ds_read_b64_tr_b16 v[44:45], v5 offset:20480
    ds_read_b64_tr_b16 v[46:47], v5 offset:21504
    s_waitcnt lgkmcnt(6)
    v_mfma_f32_32x32x16_bf16 v[64:79], v[32:35], v[148:151], v[64:79]
    ds_read_b64_tr_b16 v[16:17], v2 offset:24576
    ds_read_b64_tr_b16 v[18:19], v2 offset:25600
    s_waitcnt lgkmcnt(6)
    v_mfma_f32_32x32x16_bf16 v[80:95], v[36:39], v[148:151], v[80:95]
    ds_read_b64_tr_b16 v[20:21], v3 offset:24576
    ds_read_b64_tr_b16 v[22:23], v3 offset:25600
    s_waitcnt lgkmcnt(6)
    v_mfma_f32_32x32x16_bf16 v[96:111], v[40:43], v[148:151], v[96:111]
    ds_read_b64_tr_b16 v[24:25], v4 offset:24576
    ds_read_b64_tr_b16 v[26:27], v4 offset:25600
    s_waitcnt lgkmcnt(6)
    v_mfma_f32_32x32x16_bf16 v[112:127], v[44:47], v[148:151], v[112:127]
    ds_read_b64_tr_b16 v[28:29], v5 offset:24576
    ds_read_b64_tr_b16 v[30:31], v5 offset:25600
    s_waitcnt lgkmcnt(6)
    v_mfma_f32_32x32x16_bf16 v[64:79], v[16:19], v[152:155], v[64:79]
    ds_read_b64_tr_b16 v[32:33], v2 offset:28672
    ds_read_b64_tr_b16 v[34:35], v2 offset:29696
    s_add_u32 s26, s26, 1
    s_cmp_eq_u32 s26, 4
    s_cselect_b32 s26, 0, s26
    s_cselect_b32 s27, 4294868992, s28
    v_add_u32 v12, 1, v12
    v_lshlrev_b32 v11, 2, s26
    s_waitcnt lgkmcnt(6)
    v_mfma_f32_32x32x16_bf16 v[80:95], v[20:23], v[152:155], v[80:95]
    ds_read_b64_tr_b16 v[36:37], v3 offset:28672
    ds_read_b64_tr_b16 v[38:39], v3 offset:29696
    s_waitcnt lgkmcnt(6)
    v_mfma_f32_32x32x16_bf16 v[96:111], v[24:27], v[152:155], v[96:111]
    ds_read_b64_tr_b16 v[40:41], v4 offset:28672
    ds_read_b64_tr_b16 v[42:43], v4 offset:29696
    s_waitcnt lgkmcnt(6)
    v_mfma_f32_32x32x16_bf16 v[112:127], v[28:31], v[152:155], v[112:127]
    ds_read_b64_tr_b16 v[44:45], v5 offset:28672
    ds_read_b64_tr_b16 v[46:47], v5 offset:29696
    ds_write_b32 v13, v12
    ds_read_b32 v10, v11
    s_waitcnt lgkmcnt(8)
    v_mfma_f32_32x32x16_bf16 v[64:79], v[32:35], v[156:159], v[64:79]
    v_add_u32 v2, s27, v2
    v_add_u32 v3, s27, v3
    v_add_u32 v4, s27, v4
    v_add_u32 v5, s27, v5
    s_waitcnt lgkmcnt(6)
    v_mfma_f32_32x32x16_bf16 v[80:95], v[36:39], v[156:159], v[80:95]
L_rc3:
    s_waitcnt lgkmcnt(0)
    v_cmp_le_u32 vcc, v10, v12
    s_cbranch_vccnz L_rw3
L_rx3:
    ds_read_b64_tr_b16 v[16:17], v2 offset:0
    ds_read_b64_tr_b16 v[18:19], v2 offset:1024
    v_mfma_f32_32x32x16_bf16 v[96:111], v[40:43], v[156:159], v[96:111]
    ds_read_b64_tr_b16 v[20:21], v3 offset:0
    ds_read_b64_tr_b16 v[22:23], v3 offset:1024
    ds_read_b64_tr_b16 v[24:25], v4 offset:0
    ds_read_b64_tr_b16 v[26:27], v4 offset:1024
    v_mfma_f32_32x32x16_bf16 v[112:127], v[44:47], v[156:159], v[112:127]
    ds_read_b64_tr_b16 v[28:29], v5 offset:0
    ds_read_b64_tr_b16 v[30:31], v5 offset:1024
    s_waitcnt vmcnt(0)
    s_waitcnt lgkmcnt(6)
    v_mfma_f32_32x32x16_bf16 v[64:79], v[16:19], v[160:163], v[64:79]
    ds_read_b64_tr_b16 v[32:33], v2 offset:4096
    ds_read_b64_tr_b16 v[34:35], v2 offset:5120
    s_waitcnt lgkmcnt(6)
    v_mfma_f32_32x32x16_bf16 v[80:95], v[20:23], v[160:163], v[80:95]
    ds_read_b64_tr_b16 v[36:37], v3 offset:4096
    ds_read_b64_tr_b16 v[38:39], v3 offset:5120
    s_lshr_b32 s101, s101, 4
    s_and_b32 s8, s101, 7
    s_xor_b32 s8, s8, s20
    v_cmp_eq_u32 vcc, -1, v8
    s_nop 0
    s_bitcmp1_b32 vcc_lo, s8
    s_cbranch_scc1 L_fr2
L_fo2:
    s_lshl_b32 s8, s8, 16
    s_add_u32 s8, s8, s24
    s_add_u32 s9, s8, 4096
    buffer_load_dwordx4 v[192:195], v1, s[44:47], s8 offen offset:0 sc1
    buffer_load_dwordx4 v[196:199], v1, s[44:47], s8 offen offset:1024 sc1
    buffer_load_dwordx4 v[200:203], v1, s[44:47], s8 offen offset:2048 sc1
    buffer_load_dwordx4 v[204:207], v1, s[44:47], s8 offen offset:3072 sc1
    buffer_load_dwordx4 v[208:211], v1, s[44:47], s9 offen offset:0 sc1
    buffer_load_dwordx4 v[212:215], v1, s[44:47], s9 offen offset:1024 sc1
    buffer_load_dwordx4 v[216:219], v1, s[44:47], s9 offen offset:2048 sc1
    buffer_load_dwordx4 v[220:223], v1, s[44:47], s9 offen offset:3072 sc1
    s_waitcnt lgkmcnt(6)
    v_mfma_f32_32x32x16_bf16 v[96:111], v[24:27], v[160:163], v[96:111]
    ds_read_b64_tr_b16 v[40:41], v4 offset:4096
    ds_read_b64_tr_b16 v[42:43], v4 offset:5120
    s_waitcnt lgkmcnt(6)
    v_mfma_f32_32x32x16_bf16 v[112:127], v[28:31], v[160:163], v[112:127]
    ds_read_b64_tr_b16 v[44:45], v5 offset:4096
    ds_read_b64_tr_b16 v[46:47], v5 offset:5120
    s_waitcnt lgkmcnt(6)
    v_mfma_f32_32x32x16_bf16 v[64:79], v[32:35], v[164:167], v[64:79]
    ds_read_b64_tr_b16 v[16:17], v2 offset:8192
    ds_read_b64_tr_b16 v[18:19], v2 offset:9216
    s_waitcnt lgkmcnt(6)
    v_mfma_f32_32x32x16_bf16 v[80:95], v[36:39], v[164:167], v[80:95]
    ds_read_b64_tr_b16 v[20:21], v3 offset:8192
    ds_read_b64_tr_b16 v[22:23], v3 offset:9216
    s_waitcnt lgkmcnt(6)
    v_mfma_f32_32x32x16_bf16 v[96:111], v[40:43], v[164:167], v[96:111]
    ds_read_b64_tr_b16 v[24:25], v4 offset:8192
    ds_read_b64_tr_b16 v[26:27], v4 offset:9216
    s_waitcnt lgkmcnt(6)
    v_mfma_f32_32x32x16_bf16 v[112:127], v[44:47], v[164:167], v[112:127]
    ds_read_b64_tr_b16 v[28:29], v5 offset:8192
    ds_read_b64_tr_b16 v[30:31], v5 offset:9216
    s_waitcnt lgkmcnt(6)
    v_mfma_f32_32x32x16_bf16 v[64:79], v[16:19], v[168:171], v[64:79]
    ds_read_b64_tr_b16 v[32:33], v2 offset:12288
    ds_read_b64_tr_b16 v[34:35], v2 offset:13312
    s_waitcnt lgkmcnt(6)
    v_mfma_f32_32x32x16_bf16 v[80:95], v[20:23], v[168:171], v[80:95]
    ds_read_b64_tr_b16 v[36:37], v3 offset:12288
    ds_read_b64_tr_b16 v[38:39], v3 offset:13312
    s_waitcnt lgkmcnt(6)
    v_mfma_f32_32x32x16_bf16 v[96:111], v[24:27], v[168:171], v[96:111]
    ds_read_b64_tr_b16 v[40:41], v4 offset:12288
    ds_read_b64_tr_b16 v[42:43], v4 offset:13312
    s_waitcnt lgkmcnt(6)
    v_mfma_f32_32x32x16_bf16 v[112:127], v[28:31], v[168:171], v[112:127]
    ds_read_b64_tr_b16 v[44:45], v5 offset:12288
    ds_read_b64_tr_b16 v[46:47], v5 offset:13312
    s_waitcnt lgkmcnt(6)
    v_mfma_f32_32x32x16_bf16 v[64:79], v[32:35], v[172:175], v[64:79]
    ds_read_b64_tr_b16 v[16:17], v2 offset:16384
    ds_read_b64_tr_b16 v[18:19], v2 offset:17408
    s_waitcnt lgkmcnt(6)
    v_mfma_f32_32x32x16_bf16 v[80:95], v[36:39], v[172:175], v[80:95]
    ds_read_b64_tr_b16 v[20:21], v3 offset:16384
    ds_read_b64_tr_b16 v[22:23], v3 offset:17408
    s_waitcnt lgkmcnt(6)
    v_mfma_f32_32x32x16_bf16 v[96:111], v[40:43], v[172:175], v[96:111]
    ds_read_b64_tr_b16 v[24:25], v4 offset:16384
    ds_read_b64_tr_b16 v[26:27], v4 offset:17408
    s_waitcnt lgkmcnt(6)
    v_mfma_f32_32x32x16_bf16 v[112:127], v[44:47], v[172:175], v[112:127]
    ds_read_b64_tr_b16 v[28:29], v5 offset:16384
    ds_read_b64_tr_b16 v[30:31], v5 offset:17408
    s_waitcnt lgkmcnt(6)
    v_mfma_f32_32x32x16_bf16 v[64:79], v[16:19], v[176:179], v[64:79]
    ds_read_b64_tr_b16 v[32:33], v2 offset:20480
    ds_read_b64_tr_b16 v[34:35], v2 offset:21504
    s_waitcnt lgkmcnt(6)
    v_mfma_f32_32x32x16_bf16 v[80:95], v[20:23], v[176:179], v[80:95]
    ds_read_b64_tr_b16 v[36:37], v3 offset:20480
    ds_read_b64_tr_b16 v[38:39], v3 offset:21504
    s_waitcnt lgkmcnt(6)
    v_mfma_f32_32x32x16_bf16 v[96:111], v[24:27], v[176:179], v[96:111]
    ds_read_b64_tr_b16 v[40:41], v4 offset:20480
    ds_read_b64_tr_b16 v[42:43], v4 offset:21504
    s_waitcnt lgkmcnt(6)
    v_mfma_f32_32x32x16_bf16 v[112:127], v[28:31], v[176:179], v[112:127]
    ds_read_b64_tr_b16 v[44:45], v5 offset:20480
    ds_read_b64_tr_b16 v[46:47], v5 offset:21504
    s_waitcnt lgkmcnt(6)
    v_mfma_f32_32x32x16_bf16 v[64:79], v[32:35], v[180:183], v[64:79]
    ds_read_b64_tr_b16 v[16:17], v2 offset:24576
    ds_read_b64_tr_b16 v[18:19], v2 offset:25600
    s_waitcnt lgkmcnt(6)
    v_mfma_f32_32x32x16_bf16 v[80:95], v[36:39], v[180:183], v[80:95]
    ds_read_b64_tr_b16 v[20:21], v3 offset:24576
    ds_read_b64_tr_b16 v[22:23], v3 offset:25600
    s_waitcnt lgkmcnt(6)
    v_mfma_f32_32x32x16_bf16 v[96:111], v[40:43], v[180:183], v[96:111]
    ds_read_b64_tr_b16 v[24:25], v4 offset:24576
    ds_read_b64_tr_b16 v[26:27], v4 offset:25600
    s_waitcnt lgkmcnt(6)
    v_mfma_f32_32x32x16_bf16 v[112:127], v[44:47], v[180:183], v[112:127]
    ds_read_b64_tr_b16 v[28:29], v5 offset:24576
    ds_read_b64_tr_b16 v[30:31], v5 offset:25600
    s_waitcnt lgkmcnt(6)
    v_mfma_f32_32x32x16_bf16 v[64:79], v[16:19], v[184:187], v[64:79]
    ds_read_b64_tr_b16 v[32:33], v2 offset:28672
    ds_read_b64_tr_b16 v[34:35], v2 offset:29696
    s_add_u32 s26, s26, 1
    s_cmp_eq_u32 s26, 4
    s_cselect_b32 s26, 0, s26
    s_cselect_b32 s27, 4294868992, s28
    v_add_u32 v12, 1, v12
    v_lshlrev_b32 v11, 2, s26
    s_waitcnt lgkmcnt(6)
    v_mfma_f32_32x32x16_bf16 v[80:95], v[20:23], v[184:187], v[80:95]
    ds_read_b64_tr_b16 v[36:37], v3 offset:28672
    ds_read_b64_tr_b16 v[38:39], v3 offset:29696
    s_waitcnt lgkmcnt(6)
    v_mfma_f32_32x32x16_bf16 v[96:111], v[24:27], v[184:187], v[96:111]
    ds_read_b64_tr_b16 v[40:41], v4 offset:28672
    ds_read_b64_tr_b16 v[42:43], v4 offset:29696
    s_waitcnt lgkmcnt(6)
    v_mfma_f32_32x32x16_bf16 v[112:127], v[28:31], v[184:187], v[112:127]
    ds_read_b64_tr_b16 v[44:45], v5 offset:28672
    ds_read_b64_tr_b16 v[46:47], v5 offset:29696
    ds_write_b32 v13, v12
    ds_read_b32 v10, v11
    s_waitcnt lgkmcnt(8)
    v_mfma_f32_32x32x16_bf16 v[64:79], v[32:35], v[188:191], v[64:79]
    v_add_u32 v2, s27, v2
    v_add_u32 v3, s27, v3
    v_add_u32 v4, s27, v4
    v_add_u32 v5, s27, v5
    s_waitcnt lgkmcnt(6)
    v_mfma_f32_32x32x16_bf16 v[80:95], v[36:39], v[188:191], v[80:95]
L_rc4:
    s_waitcnt lgkmcnt(0)
    v_cmp_le_u32 vcc, v10, v12
    s_cbranch_vccnz L_rw4
L_rx4:
    ds_read_b64_tr_b16 v[16:17], v2 offset:0
    ds_read_b64_tr_b16 v[18:19], v2 offset:1024
    v_mfma_f32_32x32x16_bf16 v[96:111], v[40:43], v[188:191], v[96:111]
    ds_read_b64_tr_b16 v[20:21], v3 offset:0
    ds_read_b64_tr_b16 v[22:23], v3 offset:1024
    ds_read_b64_tr_b16 v[24:25], v4 offset:0
    ds_read_b64_tr_b16 v[26:27], v4 offset:1024
    v_mfma_f32_32x32x16_bf16 v[112:127], v[44:47], v[188:191], v[112:127]
    ds_read_b64_tr_b16 v[28:29], v5 offset:0
    ds_read_b64_tr_b16 v[30:31], v5 offset:1024
    s_waitcnt vmcnt(0)
    s_waitcnt lgkmcnt(6)
    v_mfma_f32_32x32x16_bf16 v[64:79], v[16:19], v[192:195], v[64:79]
    ds_read_b64_tr_b16 v[32:33], v2 offset:4096
    ds_read_b64_tr_b16 v[34:35], v2 offset:5120
    s_waitcnt lgkmcnt(6)
    v_mfma_f32_32x32x16_bf16 v[80:95], v[20:23], v[192:195], v[80:95]
    ds_read_b64_tr_b16 v[36:37], v3 offset:4096
    ds_read_b64_tr_b16 v[38:39], v3 offset:5120
    s_lshr_b32 s101, s101, 4
    s_and_b32 s10, s101, 7
    s_xor_b32 s10, s10, s20
    v_cmp_eq_u32 vcc, -1, v8
    s_nop 0
    s_bitcmp1_b32 vcc_lo, s10
    s_cbranch_scc1 L_fr3
L_fo3:
    s_lshl_b32 s10, s10, 16
    s_add_u32 s10, s10, s24
    s_add_u32 s11, s10, 4096
    buffer_load_dwordx4 v[224:227], v1, s[44:47], s10 offen offset:0 sc1
    buffer_load_dwordx4 v[228:231], v1, s[44:47], s10 offen offset:1024 sc1
    buffer_load_dwordx4 v[232:235], v1, s[44:47], s10 offen offset:2048 sc1
    buffer_load_dwordx4 v[236:239], v1, s[44:47], s10 offen offset:3072 sc1
    buffer_load_dwordx4 v[240:243], v1, s[44:47], s11 offen offset:0 sc1
    buffer_load_dwordx4 v[244:247], v1, s[44:47], s11 offen offset:1024 sc1
    buffer_load_dwordx4 v[248:251], v1, s[44:47], s11 offen offset:2048 sc1
    buffer_load_dwordx4 v[252:255], v1, s[44:47], s11 offen offset:3072 sc1
    s_waitcnt lgkmcnt(6)
    v_mfma_f32_32x32x16_bf16 v[96:111], v[24:27], v[192:195], v[96:111]
    ds_read_b64_tr_b16 v[40:41], v4 offset:4096
    ds_read_b64_tr_b16 v[42:43], v4 offset:5120
    s_waitcnt lgkmcnt(6)
    v_mfma_f32_32x32x16_bf16 v[112:127], v[28:31], v[192:195], v[112:127]
    ds_read_b64_tr_b16 v[44:45], v5 offset:4096
    ds_read_b64_tr_b16 v[46:47], v5 offset:5120
    s_waitcnt lgkmcnt(6)
    v_mfma_f32_32x32x16_bf16 v[64:79], v[32:35], v[196:199], v[64:79]
    ds_read_b64_tr_b16 v[16:17], v2 offset:8192
    ds_read_b64_tr_b16 v[18:19], v2 offset:9216
    s_waitcnt lgkmcnt(6)
    v_mfma_f32_32x32x16_bf16 v[80:95], v[36:39], v[196:199], v[80:95]
    ds_read_b64_tr_b16 v[20:21], v3 offset:8192
    ds_read_b64_tr_b16 v[22:23], v3 offset:9216
    s_waitcnt lgkmcnt(6)
    v_mfma_f32_32x32x16_bf16 v[96:111], v[40:43], v[196:199], v[96:111]
    ds_read_b64_tr_b16 v[24:25], v4 offset:8192
    ds_read_b64_tr_b16 v[26:27], v4 offset:9216
    s_waitcnt lgkmcnt(6)
    v_mfma_f32_32x32x16_bf16 v[112:127], v[44:47], v[196:199], v[112:127]
    ds_read_b64_tr_b16 v[28:29], v5 offset:8192
    ds_read_b64_tr_b16 v[30:31], v5 offset:9216
    s_waitcnt lgkmcnt(6)
    v_mfma_f32_32x32x16_bf16 v[64:79], v[16:19], v[200:203], v[64:79]
    ds_read_b64_tr_b16 v[32:33], v2 offset:12288
    ds_read_b64_tr_b16 v[34:35], v2 offset:13312
    s_waitcnt lgkmcnt(6)
    v_mfma_f32_32x32x16_bf16 v[80:95], v[20:23], v[200:203], v[80:95]
    ds_read_b64_tr_b16 v[36:37], v3 offset:12288
    ds_read_b64_tr_b16 v[38:39], v3 offset:13312
    s_waitcnt lgkmcnt(6)
    v_mfma_f32_32x32x16_bf16 v[96:111], v[24:27], v[200:203], v[96:111]
    ds_read_b64_tr_b16 v[40:41], v4 offset:12288
    ds_read_b64_tr_b16 v[42:43], v4 offset:13312
    s_waitcnt lgkmcnt(6)
    v_mfma_f32_32x32x16_bf16 v[112:127], v[28:31], v[200:203], v[112:127]
    ds_read_b64_tr_b16 v[44:45], v5 offset:12288
    ds_read_b64_tr_b16 v[46:47], v5 offset:13312
    s_waitcnt lgkmcnt(6)
    v_mfma_f32_32x32x16_bf16 v[64:79], v[32:35], v[204:207], v[64:79]
    ds_read_b64_tr_b16 v[16:17], v2 offset:16384
    ds_read_b64_tr_b16 v[18:19], v2 offset:17408
    s_waitcnt lgkmcnt(6)
    v_mfma_f32_32x32x16_bf16 v[80:95], v[36:39], v[204:207], v[80:95]
    ds_read_b64_tr_b16 v[20:21], v3 offset:16384
    ds_read_b64_tr_b16 v[22:23], v3 offset:17408
    s_waitcnt lgkmcnt(6)
    v_mfma_f32_32x32x16_bf16 v[96:111], v[40:43], v[204:207], v[96:111]
    ds_read_b64_tr_b16 v[24:25], v4 offset:16384
    ds_read_b64_tr_b16 v[26:27], v4 offset:17408
    s_waitcnt lgkmcnt(6)
    v_mfma_f32_32x32x16_bf16 v[112:127], v[44:47], v[204:207], v[112:127]
    ds_read_b64_tr_b16 v[28:29], v5 offset:16384
    ds_read_b64_tr_b16 v[30:31], v5 offset:17408
    s_waitcnt lgkmcnt(6)
    v_mfma_f32_32x32x16_bf16 v[64:79], v[16:19], v[208:211], v[64:79]
    ds_read_b64_tr_b16 v[32:33], v2 offset:20480
    ds_read_b64_tr_b16 v[34:35], v2 offset:21504
    s_waitcnt lgkmcnt(6)
    v_mfma_f32_32x32x16_bf16 v[80:95], v[20:23], v[208:211], v[80:95]
    ds_read_b64_tr_b16 v[36:37], v3 offset:20480
    ds_read_b64_tr_b16 v[38:39], v3 offset:21504
    s_waitcnt lgkmcnt(6)
    v_mfma_f32_32x32x16_bf16 v[96:111], v[24:27], v[208:211], v[96:111]
    ds_read_b64_tr_b16 v[40:41], v4 offset:20480
    ds_read_b64_tr_b16 v[42:43], v4 offset:21504
    s_waitcnt lgkmcnt(6)
    v_mfma_f32_32x32x16_bf16 v[112:127], v[28:31], v[208:211], v[112:127]
    ds_read_b64_tr_b16 v[44:45], v5 offset:20480
    ds_read_b64_tr_b16 v[46:47], v5 offset:21504
    s_waitcnt lgkmcnt(6)
    v_mfma_f32_32x32x16_bf16 v[64:79], v[32:35], v[212:215], v[64:79]
    ds_read_b64_tr_b16 v[16:17], v2 offset:24576
    ds_read_b64_tr_b16 v[18:19], v2 offset:25600
    s_waitcnt lgkmcnt(6)
    v_mfma_f32_32x32x16_bf16 v[80:95], v[36:39], v[212:215], v[80:95]
    ds_read_b64_tr_b16 v[20:21], v3 offset:24576
    ds_read_b64_tr_b16 v[22:23], v3 offset:25600
    s_waitcnt lgkmcnt(6)
    v_mfma_f32_32x32x16_bf16 v[96:111], v[40:43], v[212:215], v[96:111]
    ds_read_b64_tr_b16 v[24:25], v4 offset:24576
    ds_read_b64_tr_b16 v[26:27], v4 offset:25600
    s_waitcnt lgkmcnt(6)
    v_mfma_f32_32x32x16_bf16 v[112:127], v[44:47], v[212:215], v[112:127]
    ds_read_b64_tr_b16 v[28:29], v5 offset:24576
    ds_read_b64_tr_b16 v[30:31], v5 offset:25600
    s_waitcnt lgkmcnt(6)
    v_mfma_f32_32x32x16_bf16 v[64:79], v[16:19], v[216:219], v[64:79]
    ds_read_b64_tr_b16 v[32:33], v2 offset:28672
    ds_read_b64_tr_b16 v[34:35], v2 offset:29696
    s_add_u32 s26, s26, 1
    s_cmp_eq_u32 s26, 4
    s_cselect_b32 s26, 0, s26
    s_cselect_b32 s27, 4294868992, s28
    v_add_u32 v12, 1, v12
    v_lshlrev_b32 v11, 2, s26
    s_waitcnt lgkmcnt(6)
    v_mfma_f32_32x32x16_bf16 v[80:95], v[20:23], v[216:219], v[80:95]
    ds_read_b64_tr_b16 v[36:37], v3 offset:28672
    ds_read_b64_tr_b16 v[38:39], v3 offset:29696
    s_waitcnt lgkmcnt(6)
    v_mfma_f32_32x32x16_bf16 v[96:111], v[24:27], v[216:219], v[96:111]
    ds_read_b64_tr_b16 v[40:41], v4 offset:28672
    ds_read_b64_tr_b16 v[42:43], v4 offset:29696
    s_waitcnt lgkmcnt(6)
    v_mfma_f32_32x32x16_bf16 v[112:127], v[28:31], v[216:219], v[112:127]
    ds_read_b64_tr_b16 v[44:45], v5 offset:28672
    ds_read_b64_tr_b16 v[46:47], v5 offset:29696
    ds_write_b32 v13, v12
    ds_read_b32 v10, v11
    s_waitcnt lgkmcnt(8)
    v_mfma_f32_32x32x16_bf16 v[64:79], v[32:35], v[220:223], v[64:79]
    v_add_u32 v2, s27, v2
    v_add_u32 v3, s27, v3
    v_add_u32 v4, s27, v4
    v_add_u32 v5, s27, v5
    s_waitcnt lgkmcnt(6)
    v_mfma_f32_32x32x16_bf16 v[80:95], v[36:39], v[220:223], v[80:95]
L_rc5:
    s_waitcnt lgkmcnt(0)
    v_cmp_le_u32 vcc, v10, v12
    s_cbranch_vccnz L_rw5
L_rx5:
    ds_read_b64_tr_b16 v[16:17], v2 offset:0
    ds_read_b64_tr_b16 v[18:19], v2 offset:1024
    v_mfma_f32_32x32x16_bf16 v[96:111], v[40:43], v[220:223], v[96:111]
    ds_read_b64_tr_b16 v[20:21], v3 offset:0
    ds_read_b64_tr_b16 v[22:23], v3 offset:1024
    ds_read_b64_tr_b16 v[24:25], v4 offset:0
    ds_read_b64_tr_b16 v[26:27], v4 offset:1024
    v_mfma_f32_32x32x16_bf16 v[112:127], v[44:47], v[220:223], v[112:127]
    ds_read_b64_tr_b16 v[28:29], v5 offset:0
    ds_read_b64_tr_b16 v[30:31], v5 offset:1024
    s_waitcnt vmcnt(0)
    s_waitcnt lgkmcnt(6)
    v_mfma_f32_32x32x16_bf16 v[64:79], v[16:19], v[224:227], v[64:79]
    ds_read_b64_tr_b16 v[32:33], v2 offset:4096
    ds_read_b64_tr_b16 v[34:35], v2 offset:5120
    s_waitcnt lgkmcnt(6)
    v_mfma_f32_32x32x16_bf16 v[80:95], v[20:23], v[224:227], v[80:95]
    ds_read_b64_tr_b16 v[36:37], v3 offset:4096
    ds_read_b64_tr_b16 v[38:39], v3 offset:5120
    s_lshr_b32 s101, s101, 4
    s_and_b32 s4, s101, 7
    s_xor_b32 s4, s4, s20
    v_cmp_eq_u32 vcc, -1, v8
    s_nop 0
    s_bitcmp1_b32 vcc_lo, s4
    s_cbranch_scc1 L_fr4
L_fo4:
    s_lshl_b32 s4, s4, 16
    s_add_u32 s4, s4, s24
    s_add_u32 s5, s4, 4096
    buffer_load_dwordx4 v[128:131], v1, s[44:47], s4 offen offset:0 sc1
    buffer_load_dwordx4 v[132:135], v1, s[44:47], s4 offen offset:1024 sc1
    buffer_load_dwordx4 v[136:139], v1, s[44:47], s4 offen offset:2048 sc1
    buffer_load_dwordx4 v[140:143], v1, s[44:47], s4 offen offset:3072 sc1
    buffer_load_dwordx4 v[144:147], v1, s[44:47], s5 offen offset:0 sc1
    buffer_load_dwordx4 v[148:151], v1, s[44:47], s5 offen offset:1024 sc1
    buffer_load_dwordx4 v[152:155], v1, s[44:47], s5 offen offset:2048 sc1
    buffer_load_dwordx4 v[156:159], v1, s[44:47], s5 offen offset:3072 sc1
    s_waitcnt lgkmcnt(6)
    v_mfma_f32_32x32x16_bf16 v[96:111], v[24:27], v[224:227], v[96:111]
    ds_read_b64_tr_b16 v[40:41], v4 offset:4096
    ds_read_b64_tr_b16 v[42:43], v4 offset:5120
    s_waitcnt lgkmcnt(6)
    v_mfma_f32_32x32x16_bf16 v[112:127], v[28:31], v[224:227], v[112:127]
    ds_read_b64_tr_b16 v[44:45], v5 offset:4096
    ds_read_b64_tr_b16 v[46:47], v5 offset:5120
    s_waitcnt lgkmcnt(6)
    v_mfma_f32_32x32x16_bf16 v[64:79], v[32:35], v[228:231], v[64:79]
    ds_read_b64_tr_b16 v[16:17], v2 offset:8192
    ds_read_b64_tr_b16 v[18:19], v2 offset:9216
    s_waitcnt lgkmcnt(6)
    v_mfma_f32_32x32x16_bf16 v[80:95], v[36:39], v[228:231], v[80:95]
    ds_read_b64_tr_b16 v[20:21], v3 offset:8192
    ds_read_b64_tr_b16 v[22:23], v3 offset:9216
    s_waitcnt lgkmcnt(6)
    v_mfma_f32_32x32x16_bf16 v[96:111], v[40:43], v[228:231], v[96:111]
    ds_read_b64_tr_b16 v[24:25], v4 offset:8192
    ds_read_b64_tr_b16 v[26:27], v4 offset:9216
    s_waitcnt lgkmcnt(6)
    v_mfma_f32_32x32x16_bf16 v[112:127], v[44:47], v[228:231], v[112:127]
    ds_read_b64_tr_b16 v[28:29], v5 offset:8192
    ds_read_b64_tr_b16 v[30:31], v5 offset:9216
    s_waitcnt lgkmcnt(6)
    v_mfma_f32_32x32x16_bf16 v[64:79], v[16:19], v[232:235], v[64:79]
    ds_read_b64_tr_b16 v[32:33], v2 offset:12288
    ds_read_b64_tr_b16 v[34:35], v2 offset:13312
    s_waitcnt lgkmcnt(6)
    v_mfma_f32_32x32x16_bf16 v[80:95], v[20:23], v[232:235], v[80:95]
    ds_read_b64_tr_b16 v[36:37], v3 offset:12288
    ds_read_b64_tr_b16 v[38:39], v3 offset:13312
    s_waitcnt lgkmcnt(6)
    v_mfma_f32_32x32x16_bf16 v[96:111], v[24:27], v[232:235], v[96:111]
    ds_read_b64_tr_b16 v[40:41], v4 offset:12288
    ds_read_b64_tr_b16 v[42:43], v4 offset:13312
    s_waitcnt lgkmcnt(6)
    v_mfma_f32_32x32x16_bf16 v[112:127], v[28:31], v[232:235], v[112:127]
    ds_read_b64_tr_b16 v[44:45], v5 offset:12288
    ds_read_b64_tr_b16 v[46:47], v5 offset:13312
    s_waitcnt lgkmcnt(6)
    v_mfma_f32_32x32x16_bf16 v[64:79], v[32:35], v[236:239], v[64:79]
    ds_read_b64_tr_b16 v[16:17], v2 offset:16384
    ds_read_b64_tr_b16 v[18:19], v2 offset:17408
    s_waitcnt lgkmcnt(6)
    v_mfma_f32_32x32x16_bf16 v[80:95], v[36:39], v[236:239], v[80:95]
    ds_read_b64_tr_b16 v[20:21], v3 offset:16384
    ds_read_b64_tr_b16 v[22:23], v3 offset:17408
    s_waitcnt lgkmcnt(6)
    v_mfma_f32_32x32x16_bf16 v[96:111], v[40:43], v[236:239], v[96:111]
    ds_read_b64_tr_b16 v[24:25], v4 offset:16384
    ds_read_b64_tr_b16 v[26:27], v4 offset:17408
    s_waitcnt lgkmcnt(6)
    v_mfma_f32_32x32x16_bf16 v[112:127], v[44:47], v[236:239], v[112:127]
    ds_read_b64_tr_b16 v[28:29], v5 offset:16384
    ds_read_b64_tr_b16 v[30:31], v5 offset:17408
    s_waitcnt lgkmcnt(6)
    v_mfma_f32_32x32x16_bf16 v[64:79], v[16:19], v[240:243], v[64:79]
    ds_read_b64_tr_b16 v[32:33], v2 offset:20480
    ds_read_b64_tr_b16 v[34:35], v2 offset:21504
    s_waitcnt lgkmcnt(6)
    v_mfma_f32_32x32x16_bf16 v[80:95], v[20:23], v[240:243], v[80:95]
    ds_read_b64_tr_b16 v[36:37], v3 offset:20480
    ds_read_b64_tr_b16 v[38:39], v3 offset:21504
    s_waitcnt lgkmcnt(6)
    v_mfma_f32_32x32x16_bf16 v[96:111], v[24:27], v[240:243], v[96:111]
    ds_read_b64_tr_b16 v[40:41], v4 offset:20480
    ds_read_b64_tr_b16 v[42:43], v4 offset:21504
    s_waitcnt lgkmcnt(6)
    v_mfma_f32_32x32x16_bf16 v[112:127], v[28:31], v[240:243], v[112:127]
    ds_read_b64_tr_b16 v[44:45], v5 offset:20480
    ds_read_b64_tr_b16 v[46:47], v5 offset:21504
    s_waitcnt lgkmcnt(6)
    v_mfma_f32_32x32x16_bf16 v[64:79], v[32:35], v[244:247], v[64:79]
    ds_read_b64_tr_b16 v[16:17], v2 offset:24576
    ds_read_b64_tr_b16 v[18:19], v2 offset:25600
    s_waitcnt lgkmcnt(6)
    v_mfma_f32_32x32x16_bf16 v[80:95], v[36:39], v[244:247], v[80:95]
    ds_read_b64_tr_b16 v[20:21], v3 offset:24576
    ds_read_b64_tr_b16 v[22:23], v3 offset:25600
    s_waitcnt lgkmcnt(6)
    v_mfma_f32_32x32x16_bf16 v[96:111], v[40:43], v[244:247], v[96:111]
    ds_read_b64_tr_b16 v[24:25], v4 offset:24576
    ds_read_b64_tr_b16 v[26:27], v4 offset:25600
    s_waitcnt lgkmcnt(6)
    v_mfma_f32_32x32x16_bf16 v[112:127], v[44:47], v[244:247], v[112:127]
    ds_read_b64_tr_b16 v[28:29], v5 offset:24576
    ds_read_b64_tr_b16 v[30:31], v5 offset:25600
    s_waitcnt lgkmcnt(6)
    v_mfma_f32_32x32x16_bf16 v[64:79], v[16:19], v[248:251], v[64:79]
    ds_read_b64_tr_b16 v[32:33], v2 offset:28672
    ds_read_b64_tr_b16 v[34:35], v2 offset:29696
    s_add_u32 s26, s26, 1
    s_cmp_eq_u32 s26, 4
    s_cselect_b32 s26, 0, s26
    s_cselect_b32 s27, 4294868992, s28
    v_add_u32 v12, 1, v12
    v_lshlrev_b32 v11, 2, s26
    s_waitcnt lgkmcnt(6)
    v_mfma_f32_32x32x16_bf16 v[80:95], v[20:23], v[248:251], v[80:95]
    ds_read_b64_tr_b16 v[36:37], v3 offset:28672
    ds_read_b64_tr_b16 v[38:39], v3 offset:29696
    s_waitcnt lgkmcnt(6)
    v_mfma_f32_32x32x16_bf16 v[96:111], v[24:27], v[248:251], v[96:111]
    ds_read_b64_tr_b16 v[40:41], v4 offset:28672
    ds_read_b64_tr_b16 v[42:43], v4 offset:29696
    s_waitcnt lgkmcnt(6)
    v_mfma_f32_32x32x16_bf16 v[112:127], v[28:31], v[248:251], v[112:127]
    ds_read_b64_tr_b16 v[44:45], v5 offset:28672
    ds_read_b64_tr_b16 v[46:47], v5 offset:29696
    ds_write_b32 v13, v12
    ds_read_b32 v10, v11
    s_waitcnt lgkmcnt(8)
    v_mfma_f32_32x32x16_bf16 v[64:79], v[32:35], v[252:255], v[64:79]
    v_add_u32 v2, s27, v2
    v_add_u32 v3, s27, v3
    v_add_u32 v4, s27, v4
    v_add_u32 v5, s27, v5
    s_waitcnt lgkmcnt(6)
    v_mfma_f32_32x32x16_bf16 v[80:95], v[36:39], v[252:255], v[80:95]
L_rc6:
    s_waitcnt lgkmcnt(0)
    v_cmp_le_u32 vcc, v10, v12
    s_cbranch_vccnz L_rw6
L_rx6:
    ds_read_b64_tr_b16 v[16:17], v2 offset:0
    ds_read_b64_tr_b16 v[18:19], v2 offset:1024
    v_mfma_f32_32x32x16_bf16 v[96:111], v[40:43], v[252:255], v[96:111]
    ds_read_b64_tr_b16 v[20:21], v3 offset:0
    ds_read_b64_tr_b16 v[22:23], v3 offset:1024
    ds_read_b64_tr_b16 v[24:25], v4 offset:0
    ds_read_b64_tr_b16 v[26:27], v4 offset:1024
    v_mfma_f32_32x32x16_bf16 v[112:127], v[44:47], v[252:255], v[112:127]
    ds_read_b64_tr_b16 v[28:29], v5 offset:0
    ds_read_b64_tr_b16 v[30:31], v5 offset:1024
    s_waitcnt vmcnt(0)
    s_waitcnt lgkmcnt(6)
    v_mfma_f32_32x32x16_bf16 v[64:79], v[16:19], v[128:131], v[64:79]
    ds_read_b64_tr_b16 v[32:33], v2 offset:4096
    ds_read_b64_tr_b16 v[34:35], v2 offset:5120
    s_waitcnt lgkmcnt(6)
    v_mfma_f32_32x32x16_bf16 v[80:95], v[20:23], v[128:131], v[80:95]
    ds_read_b64_tr_b16 v[36:37], v3 offset:4096
    ds_read_b64_tr_b16 v[38:39], v3 offset:5120
    s_lshr_b32 s101, s101, 4
    s_and_b32 s6, s101, 7
    s_xor_b32 s6, s6, s20
    v_cmp_eq_u32 vcc, -1, v8
    s_nop 0
    s_bitcmp1_b32 vcc_lo, s6
    s_cbranch_scc1 L_fr5
L_fo5:
    s_lshl_b32 s6, s6, 16
    s_add_u32 s6, s6, s24
    s_add_u32 s7, s6, 4096
    buffer_load_dwordx4 v[160:163], v1, s[44:47], s6 offen offset:0 sc1
    buffer_load_dwordx4 v[164:167], v1, s[44:47], s6 offen offset:1024 sc1
    buffer_load_dwordx4 v[168:171], v1, s[44:47], s6 offen offset:2048 sc1
    buffer_load_dwordx4 v[172:175], v1, s[44:47], s6 offen offset:3072 sc1
    buffer_load_dwordx4 v[176:179], v1, s[44:47], s7 offen offset:0 sc1
    buffer_load_dwordx4 v[180:183], v1, s[44:47], s7 offen offset:1024 sc1
    buffer_load_dwordx4 v[184:187], v1, s[44:47], s7 offen offset:2048 sc1
    buffer_load_dwordx4 v[188:191], v1, s[44:47], s7 offen offset:3072 sc1
    s_waitcnt lgkmcnt(6)
    v_mfma_f32_32x32x16_bf16 v[96:111], v[24:27], v[128:131], v[96:111]
    ds_read_b64_tr_b16 v[40:41], v4 offset:4096
    ds_read_b64_tr_b16 v[42:43], v4 offset:5120
    s_waitcnt lgkmcnt(6)
    v_mfma_f32_32x32x16_bf16 v[112:127], v[28:31], v[128:131], v[112:127]
    ds_read_b64_tr_b16 v[44:45], v5 offset:4096
    ds_read_b64_tr_b16 v[46:47], v5 offset:5120
    s_waitcnt lgkmcnt(6)
    v_mfma_f32_32x32x16_bf16 v[64:79], v[32:35], v[132:135], v[64:79]
    ds_read_b64_tr_b16 v[16:17], v2 offset:8192
    ds_read_b64_tr_b16 v[18:19], v2 offset:9216
    s_waitcnt lgkmcnt(6)
    v_mfma_f32_32x32x16_bf16 v[80:95], v[36:39], v[132:135], v[80:95]
    ds_read_b64_tr_b16 v[20:21], v3 offset:8192
    ds_read_b64_tr_b16 v[22:23], v3 offset:9216
    s_waitcnt lgkmcnt(6)
    v_mfma_f32_32x32x16_bf16 v[96:111], v[40:43], v[132:135], v[96:111]
    ds_read_b64_tr_b16 v[24:25], v4 offset:8192
    ds_read_b64_tr_b16 v[26:27], v4 offset:9216
    s_waitcnt lgkmcnt(6)
    v_mfma_f32_32x32x16_bf16 v[112:127], v[44:47], v[132:135], v[112:127]
    ds_read_b64_tr_b16 v[28:29], v5 offset:8192
    ds_read_b64_tr_b16 v[30:31], v5 offset:9216
    s_waitcnt lgkmcnt(6)
    v_mfma_f32_32x32x16_bf16 v[64:79], v[16:19], v[136:139], v[64:79]
    ds_read_b64_tr_b16 v[32:33], v2 offset:12288
    ds_read_b64_tr_b16 v[34:35], v2 offset:13312
    s_waitcnt lgkmcnt(6)
    v_mfma_f32_32x32x16_bf16 v[80:95], v[20:23], v[136:139], v[80:95]
    ds_read_b64_tr_b16 v[36:37], v3 offset:12288
    ds_read_b64_tr_b16 v[38:39], v3 offset:13312
    s_waitcnt lgkmcnt(6)
    v_mfma_f32_32x32x16_bf16 v[96:111], v[24:27], v[136:139], v[96:111]
    ds_read_b64_tr_b16 v[40:41], v4 offset:12288
    ds_read_b64_tr_b16 v[42:43], v4 offset:13312
    s_waitcnt lgkmcnt(6)
    v_mfma_f32_32x32x16_bf16 v[112:127], v[28:31], v[136:139], v[112:127]
    ds_read_b64_tr_b16 v[44:45], v5 offset:12288
    ds_read_b64_tr_b16 v[46:47], v5 offset:13312
    s_waitcnt lgkmcnt(6)
    v_mfma_f32_32x32x16_bf16 v[64:79], v[32:35], v[140:143], v[64:79]
    ds_read_b64_tr_b16 v[16:17], v2 offset:16384
    ds_read_b64_tr_b16 v[18:19], v2 offset:17408
    s_waitcnt lgkmcnt(6)
    v_mfma_f32_32x32x16_bf16 v[80:95], v[36:39], v[140:143], v[80:95]
    ds_read_b64_tr_b16 v[20:21], v3 offset:16384
    ds_read_b64_tr_b16 v[22:23], v3 offset:17408
    s_waitcnt lgkmcnt(6)
    v_mfma_f32_32x32x16_bf16 v[96:111], v[40:43], v[140:143], v[96:111]
    ds_read_b64_tr_b16 v[24:25], v4 offset:16384
    ds_read_b64_tr_b16 v[26:27], v4 offset:17408
    s_waitcnt lgkmcnt(6)
    v_mfma_f32_32x32x16_bf16 v[112:127], v[44:47], v[140:143], v[112:127]
    ds_read_b64_tr_b16 v[28:29], v5 offset:16384
    ds_read_b64_tr_b16 v[30:31], v5 offset:17408
    s_waitcnt lgkmcnt(6)
    v_mfma_f32_32x32x16_bf16 v[64:79], v[16:19], v[144:147], v[64:79]
    ds_read_b64_tr_b16 v[32:33], v2 offset:20480
    ds_read_b64_tr_b16 v[34:35], v2 offset:21504
    s_waitcnt lgkmcnt(6)
    v_mfma_f32_32x32x16_bf16 v[80:95], v[20:23], v[144:147], v[80:95]
    ds_read_b64_tr_b16 v[36:37], v3 offset:20480
    ds_read_b64_tr_b16 v[38:39], v3 offset:21504
    s_waitcnt lgkmcnt(6)
    v_mfma_f32_32x32x16_bf16 v[96:111], v[24:27], v[144:147], v[96:111]
    ds_read_b64_tr_b16 v[40:41], v4 offset:20480
    ds_read_b64_tr_b16 v[42:43], v4 offset:21504
    s_waitcnt lgkmcnt(6)
    v_mfma_f32_32x32x16_bf16 v[112:127], v[28:31], v[144:147], v[112:127]
    ds_read_b64_tr_b16 v[44:45], v5 offset:20480
    ds_read_b64_tr_b16 v[46:47], v5 offset:21504
    s_waitcnt lgkmcnt(6)
    v_mfma_f32_32x32x16_bf16 v[64:79], v[32:35], v[148:151], v[64:79]
    ds_read_b64_tr_b16 v[16:17], v2 offset:24576
    ds_read_b64_tr_b16 v[18:19], v2 offset:25600
    s_waitcnt lgkmcnt(6)
    v_mfma_f32_32x32x16_bf16 v[80:95], v[36:39], v[148:151], v[80:95]
    ds_read_b64_tr_b16 v[20:21], v3 offset:24576
    ds_read_b64_tr_b16 v[22:23], v3 offset:25600
    s_waitcnt lgkmcnt(6)
    v_mfma_f32_32x32x16_bf16 v[96:111], v[40:43], v[148:151], v[96:111]
    ds_read_b64_tr_b16 v[24:25], v4 offset:24576
    ds_read_b64_tr_b16 v[26:27], v4 offset:25600
    s_waitcnt lgkmcnt(6)
    v_mfma_f32_32x32x16_bf16 v[112:127], v[44:47], v[148:151], v[112:127]
    ds_read_b64_tr_b16 v[28:29], v5 offset:24576
    ds_read_b64_tr_b16 v[30:31], v5 offset:25600
    s_waitcnt lgkmcnt(6)
    v_mfma_f32_32x32x16_bf16 v[64:79], v[16:19], v[152:155], v[64:79]
    ds_read_b64_tr_b16 v[32:33], v2 offset:28672
    ds_read_b64_tr_b16 v[34:35], v2 offset:29696
    s_add_u32 s26, s26, 1
    s_cmp_eq_u32 s26, 4
    s_cselect_b32 s26, 0, s26
    s_cselect_b32 s27, 4294868992, s28
    v_add_u32 v12, 1, v12
    v_lshlrev_b32 v11, 2, s26
    s_waitcnt lgkmcnt(6)
    v_mfma_f32_32x32x16_bf16 v[80:95], v[20:23], v[152:155], v[80:95]
    ds_read_b64_tr_b16 v[36:37], v3 offset:28672
    ds_read_b64_tr_b16 v[38:39], v3 offset:29696
    s_waitcnt lgkmcnt(6)
    v_mfma_f32_32x32x16_bf16 v[96:111], v[24:27], v[152:155], v[96:111]
    ds_read_b64_tr_b16 v[40:41], v4 offset:28672
    ds_read_b64_tr_b16 v[42:43], v4 offset:29696
    s_waitcnt lgkmcnt(6)
    v_mfma_f32_32x32x16_bf16 v[112:127], v[28:31], v[152:155], v[112:127]
    ds_read_b64_tr_b16 v[44:45], v5 offset:28672
    ds_read_b64_tr_b16 v[46:47], v5 offset:29696
    ds_write_b32 v13, v12
    ds_read_b32 v10, v11
    s_waitcnt lgkmcnt(8)
    v_mfma_f32_32x32x16_bf16 v[64:79], v[32:35], v[156:159], v[64:79]
    v_add_u32 v2, s27, v2
    v_add_u32 v3, s27, v3
    v_add_u32 v4, s27, v4
    v_add_u32 v5, s27, v5
    s_waitcnt lgkmcnt(6)
    v_mfma_f32_32x32x16_bf16 v[80:95], v[36:39], v[156:159], v[80:95]
L_rc7:
    s_waitcnt lgkmcnt(0)
    v_cmp_le_u32 vcc, v10, v12
    s_cbranch_vccnz L_rw7
L_rx7:
    ds_read_b64_tr_b16 v[16:17], v2 offset:0
    ds_read_b64_tr_b16 v[18:19], v2 offset:1024
    v_mfma_f32_32x32x16_bf16 v[96:111], v[40:43], v[156:159], v[96:111]
    ds_read_b64_tr_b16 v[20:21], v3 offset:0
    ds_read_b64_tr_b16 v[22:23], v3 offset:1024
    ds_read_b64_tr_b16 v[24:25], v4 offset:0
    ds_read_b64_tr_b16 v[26:27], v4 offset:1024
    v_mfma_f32_32x32x16_bf16 v[112:127], v[44:47], v[156:159], v[112:127]
    ds_read_b64_tr_b16 v[28:29], v5 offset:0
    ds_read_b64_tr_b16 v[30:31], v5 offset:1024
    s_waitcnt vmcnt(0)
    s_waitcnt lgkmcnt(6)
    v_mfma_f32_32x32x16_bf16 v[64:79], v[16:19], v[160:163], v[64:79]
    ds_read_b64_tr_b16 v[32:33], v2 offset:4096
    ds_read_b64_tr_b16 v[34:35], v2 offset:5120
    s_waitcnt lgkmcnt(6)
    v_mfma_f32_32x32x16_bf16 v[80:95], v[20:23], v[160:163], v[80:95]
    ds_read_b64_tr_b16 v[36:37], v3 offset:4096
    ds_read_b64_tr_b16 v[38:39], v3 offset:5120
    s_lshr_b32 s101, s101, 4
    s_and_b32 s8, s101, 7
    s_xor_b32 s8, s8, s20
    v_cmp_eq_u32 vcc, -1, v8
    s_nop 0
    s_bitcmp1_b32 vcc_lo, s8
    s_cbranch_scc1 L_fr6
L_fo6:
    s_lshl_b32 s8, s8, 16
    s_add_u32 s8, s8, s24
    s_add_u32 s9, s8, 4096
    buffer_load_dwordx4 v[192:195], v1, s[44:47], s8 offen offset:0 sc1
    buffer_load_dwordx4 v[196:199], v1, s[44:47], s8 offen offset:1024 sc1
    buffer_load_dwordx4 v[200:203], v1, s[44:47], s8 offen offset:2048 sc1
    buffer_load_dwordx4 v[204:207], v1, s[44:47], s8 offen offset:3072 sc1
    buffer_load_dwordx4 v[208:211], v1, s[44:47], s9 offen offset:0 sc1
    buffer_load_dwordx4 v[212:215], v1, s[44:47], s9 offen offset:1024 sc1
    buffer_load_dwordx4 v[216:219], v1, s[44:47], s9 offen offset:2048 sc1
    buffer_load_dwordx4 v[220:223], v1, s[44:47], s9 offen offset:3072 sc1
    s_waitcnt lgkmcnt(6)
    v_mfma_f32_32x32x16_bf16 v[96:111], v[24:27], v[160:163], v[96:111]
    ds_read_b64_tr_b16 v[40:41], v4 offset:4096
    ds_read_b64_tr_b16 v[42:43], v4 offset:5120
    s_waitcnt lgkmcnt(6)
    v_mfma_f32_32x32x16_bf16 v[112:127], v[28:31], v[160:163], v[112:127]
    ds_read_b64_tr_b16 v[44:45], v5 offset:4096
    ds_read_b64_tr_b16 v[46:47], v5 offset:5120
    s_waitcnt lgkmcnt(6)
    v_mfma_f32_32x32x16_bf16 v[64:79], v[32:35], v[164:167], v[64:79]
    ds_read_b64_tr_b16 v[16:17], v2 offset:8192
    ds_read_b64_tr_b16 v[18:19], v2 offset:9216
    s_waitcnt lgkmcnt(6)
    v_mfma_f32_32x32x16_bf16 v[80:95], v[36:39], v[164:167], v[80:95]
    ds_read_b64_tr_b16 v[20:21], v3 offset:8192
    ds_read_b64_tr_b16 v[22:23], v3 offset:9216
    s_waitcnt lgkmcnt(6)
    v_mfma_f32_32x32x16_bf16 v[96:111], v[40:43], v[164:167], v[96:111]
    ds_read_b64_tr_b16 v[24:25], v4 offset:8192
    ds_read_b64_tr_b16 v[26:27], v4 offset:9216
    s_waitcnt lgkmcnt(6)
    v_mfma_f32_32x32x16_bf16 v[112:127], v[44:47], v[164:167], v[112:127]
    ds_read_b64_tr_b16 v[28:29], v5 offset:8192
    ds_read_b64_tr_b16 v[30:31], v5 offset:9216
    s_waitcnt lgkmcnt(6)
    v_mfma_f32_32x32x16_bf16 v[64:79], v[16:19], v[168:171], v[64:79]
    ds_read_b64_tr_b16 v[32:33], v2 offset:12288
    ds_read_b64_tr_b16 v[34:35], v2 offset:13312
    s_waitcnt lgkmcnt(6)
    v_mfma_f32_32x32x16_bf16 v[80:95], v[20:23], v[168:171], v[80:95]
    ds_read_b64_tr_b16 v[36:37], v3 offset:12288
    ds_read_b64_tr_b16 v[38:39], v3 offset:13312
    s_waitcnt lgkmcnt(6)
    v_mfma_f32_32x32x16_bf16 v[96:111], v[24:27], v[168:171], v[96:111]
    ds_read_b64_tr_b16 v[40:41], v4 offset:12288
    ds_read_b64_tr_b16 v[42:43], v4 offset:13312
    s_waitcnt lgkmcnt(6)
    v_mfma_f32_32x32x16_bf16 v[112:127], v[28:31], v[168:171], v[112:127]
    ds_read_b64_tr_b16 v[44:45], v5 offset:12288
    ds_read_b64_tr_b16 v[46:47], v5 offset:13312
    s_waitcnt lgkmcnt(6)
    v_mfma_f32_32x32x16_bf16 v[64:79], v[32:35], v[172:175], v[64:79]
    ds_read_b64_tr_b16 v[16:17], v2 offset:16384
    ds_read_b64_tr_b16 v[18:19], v2 offset:17408
    s_waitcnt lgkmcnt(6)
    v_mfma_f32_32x32x16_bf16 v[80:95], v[36:39], v[172:175], v[80:95]
    ds_read_b64_tr_b16 v[20:21], v3 offset:16384
    ds_read_b64_tr_b16 v[22:23], v3 offset:17408
    s_waitcnt lgkmcnt(6)
    v_mfma_f32_32x32x16_bf16 v[96:111], v[40:43], v[172:175], v[96:111]
    ds_read_b64_tr_b16 v[24:25], v4 offset:16384
    ds_read_b64_tr_b16 v[26:27], v4 offset:17408
    s_waitcnt lgkmcnt(6)
    v_mfma_f32_32x32x16_bf16 v[112:127], v[44:47], v[172:175], v[112:127]
    ds_read_b64_tr_b16 v[28:29], v5 offset:16384
    ds_read_b64_tr_b16 v[30:31], v5 offset:17408
    s_waitcnt lgkmcnt(6)
    v_mfma_f32_32x32x16_bf16 v[64:79], v[16:19], v[176:179], v[64:79]
    ds_read_b64_tr_b16 v[32:33], v2 offset:20480
    ds_read_b64_tr_b16 v[34:35], v2 offset:21504
    s_waitcnt lgkmcnt(6)
    v_mfma_f32_32x32x16_bf16 v[80:95], v[20:23], v[176:179], v[80:95]
    ds_read_b64_tr_b16 v[36:37], v3 offset:20480
    ds_read_b64_tr_b16 v[38:39], v3 offset:21504
    s_waitcnt lgkmcnt(6)
    v_mfma_f32_32x32x16_bf16 v[96:111], v[24:27], v[176:179], v[96:111]
    ds_read_b64_tr_b16 v[40:41], v4 offset:20480
    ds_read_b64_tr_b16 v[42:43], v4 offset:21504
    s_waitcnt lgkmcnt(6)
    v_mfma_f32_32x32x16_bf16 v[112:127], v[28:31], v[176:179], v[112:127]
    ds_read_b64_tr_b16 v[44:45], v5 offset:20480
    ds_read_b64_tr_b16 v[46:47], v5 offset:21504
    s_waitcnt lgkmcnt(6)
    v_mfma_f32_32x32x16_bf16 v[64:79], v[32:35], v[180:183], v[64:79]
    ds_read_b64_tr_b16 v[16:17], v2 offset:24576
    ds_read_b64_tr_b16 v[18:19], v2 offset:25600
    s_waitcnt lgkmcnt(6)
    v_mfma_f32_32x32x16_bf16 v[80:95], v[36:39], v[180:183], v[80:95]
    ds_read_b64_tr_b16 v[20:21], v3 offset:24576
    ds_read_b64_tr_b16 v[22:23], v3 offset:25600
    s_waitcnt lgkmcnt(6)
    v_mfma_f32_32x32x16_bf16 v[96:111], v[40:43], v[180:183], v[96:111]
    ds_read_b64_tr_b16 v[24:25], v4 offset:24576
    ds_read_b64_tr_b16 v[26:27], v4 offset:25600
    s_waitcnt lgkmcnt(6)
    v_mfma_f32_32x32x16_bf16 v[112:127], v[44:47], v[180:183], v[112:127]
    ds_read_b64_tr_b16 v[28:29], v5 offset:24576
    ds_read_b64_tr_b16 v[30:31], v5 offset:25600
    s_waitcnt lgkmcnt(6)
    v_mfma_f32_32x32x16_bf16 v[64:79], v[16:19], v[184:187], v[64:79]
    ds_read_b64_tr_b16 v[32:33], v2 offset:28672
    ds_read_b64_tr_b16 v[34:35], v2 offset:29696
    s_add_u32 s26, s26, 1
    s_cmp_eq_u32 s26, 4
    s_cselect_b32 s26, 0, s26
    s_cselect_b32 s27, 4294868992, s28
    v_add_u32 v12, 1, v12
    v_lshlrev_b32 v11, 2, s26
    s_waitcnt lgkmcnt(6)
    v_mfma_f32_32x32x16_bf16 v[80:95], v[20:23], v[184:187], v[80:95]
    ds_read_b64_tr_b16 v[36:37], v3 offset:28672
    ds_read_b64_tr_b16 v[38:39], v3 offset:29696
    s_waitcnt lgkmcnt(6)
    v_mfma_f32_32x32x16_bf16 v[96:111], v[24:27], v[184:187], v[96:111]
    ds_read_b64_tr_b16 v[40:41], v4 offset:28672
    ds_read_b64_tr_b16 v[42:43], v4 offset:29696
    s_waitcnt lgkmcnt(6)
    v_mfma_f32_32x32x16_bf16 v[112:127], v[28:31], v[184:187], v[112:127]
    ds_read_b64_tr_b16 v[44:45], v5 offset:28672
    ds_read_b64_tr_b16 v[46:47], v5 offset:29696
    ds_write_b32 v13, v12
    ds_read_b32 v10, v11
    s_waitcnt lgkmcnt(8)
    v_mfma_f32_32x32x16_bf16 v[64:79], v[32:35], v[188:191], v[64:79]
    v_add_u32 v2, s27, v2
    v_add_u32 v3, s27, v3
    v_add_u32 v4, s27, v4
    v_add_u32 v5, s27, v5
    s_waitcnt lgkmcnt(6)
    v_mfma_f32_32x32x16_bf16 v[80:95], v[36:39], v[188:191], v[80:95]
L_rc8:
    s_waitcnt lgkmcnt(0)
    v_cmp_le_u32 vcc, v10, v12
    s_cbranch_vccnz L_rw8
L_rx8:
    ds_read_b64_tr_b16 v[16:17], v2 offset:0
    ds_read_b64_tr_b16 v[18:19], v2 offset:1024
    v_mfma_f32_32x32x16_bf16 v[96:111], v[40:43], v[188:191], v[96:111]
    ds_read_b64_tr_b16 v[20:21], v3 offset:0
    ds_read_b64_tr_b16 v[22:23], v3 offset:1024
    ds_read_b64_tr_b16 v[24:25], v4 offset:0
    ds_read_b64_tr_b16 v[26:27], v4 offset:1024
    v_mfma_f32_32x32x16_bf16 v[112:127], v[44:47], v[188:191], v[112:127]
    ds_read_b64_tr_b16 v[28:29], v5 offset:0
    ds_read_b64_tr_b16 v[30:31], v5 offset:1024
    s_waitcnt vmcnt(0)
    s_waitcnt lgkmcnt(6)
    v_mfma_f32_32x32x16_bf16 v[64:79], v[16:19], v[192:195], v[64:79]
    ds_read_b64_tr_b16 v[32:33], v2 offset:4096
    ds_read_b64_tr_b16 v[34:35], v2 offset:5120
    s_waitcnt lgkmcnt(6)
    v_mfma_f32_32x32x16_bf16 v[80:95], v[20:23], v[192:195], v[80:95]
    ds_read_b64_tr_b16 v[36:37], v3 offset:4096
    ds_read_b64_tr_b16 v[38:39], v3 offset:5120
    s_lshr_b32 s101, s101, 4
    s_and_b32 s10, s101, 7
    s_xor_b32 s10, s10, s20
    v_cmp_eq_u32 vcc, -1, v8
    s_nop 0
    s_bitcmp1_b32 vcc_lo, s10
    s_cbranch_scc1 L_fr7
L_fo7:
    s_lshl_b32 s10, s10, 16
    s_add_u32 s10, s10, s24
    s_add_u32 s11, s10, 4096
    buffer_load_dwordx4 v[224:227], v1, s[44:47], s10 offen offset:0 sc1
    buffer_load_dwordx4 v[228:231], v1, s[44:47], s10 offen offset:1024 sc1
    buffer_load_dwordx4 v[232:235], v1, s[44:47], s10 offen offset:2048 sc1
    buffer_load_dwordx4 v[236:239], v1, s[44:47], s10 offen offset:3072 sc1
    buffer_load_dwordx4 v[240:243], v1, s[44:47], s11 offen offset:0 sc1
    buffer_load_dwordx4 v[244:247], v1, s[44:47], s11 offen offset:1024 sc1
    buffer_load_dwordx4 v[248:251], v1, s[44:47], s11 offen offset:2048 sc1
    buffer_load_dwordx4 v[252:255], v1, s[44:47], s11 offen offset:3072 sc1
    s_waitcnt lgkmcnt(6)
    v_mfma_f32_32x32x16_bf16 v[96:111], v[24:27], v[192:195], v[96:111]
    ds_read_b64_tr_b16 v[40:41], v4 offset:4096
    ds_read_b64_tr_b16 v[42:43], v4 offset:5120
    s_waitcnt lgkmcnt(6)
    v_mfma_f32_32x32x16_bf16 v[112:127], v[28:31], v[192:195], v[112:127]
    ds_read_b64_tr_b16 v[44:45], v5 offset:4096
    ds_read_b64_tr_b16 v[46:47], v5 offset:5120
    s_waitcnt lgkmcnt(6)
    v_mfma_f32_32x32x16_bf16 v[64:79], v[32:35], v[196:199], v[64:79]
    ds_read_b64_tr_b16 v[16:17], v2 offset:8192
    ds_read_b64_tr_b16 v[18:19], v2 offset:9216
    s_waitcnt lgkmcnt(6)
    v_mfma_f32_32x32x16_bf16 v[80:95], v[36:39], v[196:199], v[80:95]
    ds_read_b64_tr_b16 v[20:21], v3 offset:8192
    ds_read_b64_tr_b16 v[22:23], v3 offset:9216
    s_waitcnt lgkmcnt(6)
    v_mfma_f32_32x32x16_bf16 v[96:111], v[40:43], v[196:199], v[96:111]
    ds_read_b64_tr_b16 v[24:25], v4 offset:8192
    ds_read_b64_tr_b16 v[26:27], v4 offset:9216
    s_waitcnt lgkmcnt(6)
    v_mfma_f32_32x32x16_bf16 v[112:127], v[44:47], v[196:199], v[112:127]
    ds_read_b64_tr_b16 v[28:29], v5 offset:8192
    ds_read_b64_tr_b16 v[30:31], v5 offset:9216
    s_waitcnt lgkmcnt(6)
    v_mfma_f32_32x32x16_bf16 v[64:79], v[16:19], v[200:203], v[64:79]
    ds_read_b64_tr_b16 v[32:33], v2 offset:12288
    ds_read_b64_tr_b16 v[34:35], v2 offset:13312
    s_waitcnt lgkmcnt(6)
    v_mfma_f32_32x32x16_bf16 v[80:95], v[20:23], v[200:203], v[80:95]
    ds_read_b64_tr_b16 v[36:37], v3 offset:12288
    ds_read_b64_tr_b16 v[38:39], v3 offset:13312
    s_waitcnt lgkmcnt(6)
    v_mfma_f32_32x32x16_bf16 v[96:111], v[24:27], v[200:203], v[96:111]
    ds_read_b64_tr_b16 v[40:41], v4 offset:12288
    ds_read_b64_tr_b16 v[42:43], v4 offset:13312
    s_waitcnt lgkmcnt(6)
    v_mfma_f32_32x32x16_bf16 v[112:127], v[28:31], v[200:203], v[112:127]
    ds_read_b64_tr_b16 v[44:45], v5 offset:12288
    ds_read_b64_tr_b16 v[46:47], v5 offset:13312
    s_waitcnt lgkmcnt(6)
    v_mfma_f32_32x32x16_bf16 v[64:79], v[32:35], v[204:207], v[64:79]
    ds_read_b64_tr_b16 v[16:17], v2 offset:16384
    ds_read_b64_tr_b16 v[18:19], v2 offset:17408
    s_waitcnt lgkmcnt(6)
    v_mfma_f32_32x32x16_bf16 v[80:95], v[36:39], v[204:207], v[80:95]
    ds_read_b64_tr_b16 v[20:21], v3 offset:16384
    ds_read_b64_tr_b16 v[22:23], v3 offset:17408
    s_waitcnt lgkmcnt(6)
    v_mfma_f32_32x32x16_bf16 v[96:111], v[40:43], v[204:207], v[96:111]
    ds_read_b64_tr_b16 v[24:25], v4 offset:16384
    ds_read_b64_tr_b16 v[26:27], v4 offset:17408
    s_waitcnt lgkmcnt(6)
    v_mfma_f32_32x32x16_bf16 v[112:127], v[44:47], v[204:207], v[112:127]
    ds_read_b64_tr_b16 v[28:29], v5 offset:16384
    ds_read_b64_tr_b16 v[30:31], v5 offset:17408
    s_waitcnt lgkmcnt(6)
    v_mfma_f32_32x32x16_bf16 v[64:79], v[16:19], v[208:211], v[64:79]
    ds_read_b64_tr_b16 v[32:33], v2 offset:20480
    ds_read_b64_tr_b16 v[34:35], v2 offset:21504
    s_waitcnt lgkmcnt(6)
    v_mfma_f32_32x32x16_bf16 v[80:95], v[20:23], v[208:211], v[80:95]
    ds_read_b64_tr_b16 v[36:37], v3 offset:20480
    ds_read_b64_tr_b16 v[38:39], v3 offset:21504
    s_waitcnt lgkmcnt(6)
    v_mfma_f32_32x32x16_bf16 v[96:111], v[24:27], v[208:211], v[96:111]
    ds_read_b64_tr_b16 v[40:41], v4 offset:20480
    ds_read_b64_tr_b16 v[42:43], v4 offset:21504
    s_waitcnt lgkmcnt(6)
    v_mfma_f32_32x32x16_bf16 v[112:127], v[28:31], v[208:211], v[112:127]
    ds_read_b64_tr_b16 v[44:45], v5 offset:20480
    ds_read_b64_tr_b16 v[46:47], v5 offset:21504
    s_waitcnt lgkmcnt(6)
    v_mfma_f32_32x32x16_bf16 v[64:79], v[32:35], v[212:215], v[64:79]
    ds_read_b64_tr_b16 v[16:17], v2 offset:24576
    ds_read_b64_tr_b16 v[18:19], v2 offset:25600
    s_waitcnt lgkmcnt(6)
    v_mfma_f32_32x32x16_bf16 v[80:95], v[36:39], v[212:215], v[80:95]
    ds_read_b64_tr_b16 v[20:21], v3 offset:24576
    ds_read_b64_tr_b16 v[22:23], v3 offset:25600
    s_waitcnt lgkmcnt(6)
    v_mfma_f32_32x32x16_bf16 v[96:111], v[40:43], v[212:215], v[96:111]
    ds_read_b64_tr_b16 v[24:25], v4 offset:24576
    ds_read_b64_tr_b16 v[26:27], v4 offset:25600
    s_waitcnt lgkmcnt(6)
    v_mfma_f32_32x32x16_bf16 v[112:127], v[44:47], v[212:215], v[112:127]
    ds_read_b64_tr_b16 v[28:29], v5 offset:24576
    ds_read_b64_tr_b16 v[30:31], v5 offset:25600
    s_waitcnt lgkmcnt(6)
    v_mfma_f32_32x32x16_bf16 v[64:79], v[16:19], v[216:219], v[64:79]
    ds_read_b64_tr_b16 v[32:33], v2 offset:28672
    ds_read_b64_tr_b16 v[34:35], v2 offset:29696
    s_add_u32 s26, s26, 1
    s_cmp_eq_u32 s26, 4
    s_cselect_b32 s26, 0, s26
    s_cselect_b32 s27, 4294868992, s28
    v_add_u32 v12, 1, v12
    v_lshlrev_b32 v11, 2, s26
    s_waitcnt lgkmcnt(6)
    v_mfma_f32_32x32x16_bf16 v[80:95], v[20:23], v[216:219], v[80:95]
    ds_read_b64_tr_b16 v[36:37], v3 offset:28672
    ds_read_b64_tr_b16 v[38:39], v3 offset:29696
    s_waitcnt lgkmcnt(6)
    v_mfma_f32_32x32x16_bf16 v[96:111], v[24:27], v[216:219], v[96:111]
    ds_read_b64_tr_b16 v[40:41], v4 offset:28672
    ds_read_b64_tr_b16 v[42:43], v4 offset:29696
    s_waitcnt lgkmcnt(6)
    v_mfma_f32_32x32x16_bf16 v[112:127], v[28:31], v[216:219], v[112:127]
    ds_read_b64_tr_b16 v[44:45], v5 offset:28672
    ds_read_b64_tr_b16 v[46:47], v5 offset:29696
    ds_write_b32 v13, v12
    ds_read_b32 v10, v11
    s_waitcnt lgkmcnt(8)
    v_mfma_f32_32x32x16_bf16 v[64:79], v[32:35], v[220:223], v[64:79]
    v_add_u32 v2, s27, v2
    v_add_u32 v3, s27, v3
    v_add_u32 v4, s27, v4
    v_add_u32 v5, s27, v5
    s_waitcnt lgkmcnt(6)
    v_mfma_f32_32x32x16_bf16 v[80:95], v[36:39], v[220:223], v[80:95]
L_rc9:
    s_waitcnt lgkmcnt(0)
    v_cmp_le_u32 vcc, v10, v12
    s_cbranch_vccnz L_rw9
L_rx9:
    ds_read_b64_tr_b16 v[16:17], v2 offset:0
    ds_read_b64_tr_b16 v[18:19], v2 offset:1024
    v_mfma_f32_32x32x16_bf16 v[96:111], v[40:43], v[220:223], v[96:111]
    ds_read_b64_tr_b16 v[20:21], v3 offset:0
    ds_read_b64_tr_b16 v[22:23], v3 offset:1024
    ds_read_b64_tr_b16 v[24:25], v4 offset:0
    ds_read_b64_tr_b16 v[26:27], v4 offset:1024
    v_mfma_f32_32x32x16_bf16 v[112:127], v[44:47], v[220:223], v[112:127]
    ds_read_b64_tr_b16 v[28:29], v5 offset:0
    ds_read_b64_tr_b16 v[30:31], v5 offset:1024
    s_waitcnt vmcnt(0)
    s_waitcnt lgkmcnt(6)
    v_mfma_f32_32x32x16_bf16 v[64:79], v[16:19], v[224:227], v[64:79]
    ds_read_b64_tr_b16 v[32:33], v2 offset:4096
    ds_read_b64_tr_b16 v[34:35], v2 offset:5120
    s_waitcnt lgkmcnt(6)
    v_mfma_f32_32x32x16_bf16 v[80:95], v[20:23], v[224:227], v[80:95]
    ds_read_b64_tr_b16 v[36:37], v3 offset:4096
    ds_read_b64_tr_b16 v[38:39], v3 offset:5120
    s_waitcnt lgkmcnt(6)
    v_mfma_f32_32x32x16_bf16 v[96:111], v[24:27], v[224:227], v[96:111]
    ds_read_b64_tr_b16 v[40:41], v4 offset:4096
    ds_read_b64_tr_b16 v[42:43], v4 offset:5120
    s_waitcnt lgkmcnt(6)
    v_mfma_f32_32x32x16_bf16 v[112:127], v[28:31], v[224:227], v[112:127]
    ds_read_b64_tr_b16 v[44:45], v5 offset:4096
    ds_read_b64_tr_b16 v[46:47], v5 offset:5120
    s_waitcnt lgkmcnt(6)
    v_mfma_f32_32x32x16_bf16 v[64:79], v[32:35], v[228:231], v[64:79]
    ds_read_b64_tr_b16 v[16:17], v2 offset:8192
    ds_read_b64_tr_b16 v[18:19], v2 offset:9216
    s_waitcnt lgkmcnt(6)
    v_mfma_f32_32x32x16_bf16 v[80:95], v[36:39], v[228:231], v[80:95]
    ds_read_b64_tr_b16 v[20:21], v3 offset:8192
    ds_read_b64_tr_b16 v[22:23], v3 offset:9216
    s_waitcnt lgkmcnt(6)
    v_mfma_f32_32x32x16_bf16 v[96:111], v[40:43], v[228:231], v[96:111]
    ds_read_b64_tr_b16 v[24:25], v4 offset:8192
    ds_read_b64_tr_b16 v[26:27], v4 offset:9216
    s_waitcnt lgkmcnt(6)
    v_mfma_f32_32x32x16_bf16 v[112:127], v[44:47], v[228:231], v[112:127]
    ds_read_b64_tr_b16 v[28:29], v5 offset:8192
    ds_read_b64_tr_b16 v[30:31], v5 offset:9216
    s_waitcnt lgkmcnt(6)
    v_mfma_f32_32x32x16_bf16 v[64:79], v[16:19], v[232:235], v[64:79]
    ds_read_b64_tr_b16 v[32:33], v2 offset:12288
    ds_read_b64_tr_b16 v[34:35], v2 offset:13312
    s_waitcnt lgkmcnt(6)
    v_mfma_f32_32x32x16_bf16 v[80:95], v[20:23], v[232:235], v[80:95]
    ds_read_b64_tr_b16 v[36:37], v3 offset:12288
    ds_read_b64_tr_b16 v[38:39], v3 offset:13312
    s_waitcnt lgkmcnt(6)
    v_mfma_f32_32x32x16_bf16 v[96:111], v[24:27], v[232:235], v[96:111]
    ds_read_b64_tr_b16 v[40:41], v4 offset:12288
    ds_read_b64_tr_b16 v[42:43], v4 offset:13312
    s_waitcnt lgkmcnt(6)
    v_mfma_f32_32x32x16_bf16 v[112:127], v[28:31], v[232:235], v[112:127]
    ds_read_b64_tr_b16 v[44:45], v5 offset:12288
    ds_read_b64_tr_b16 v[46:47], v5 offset:13312
    s_waitcnt lgkmcnt(6)
    v_mfma_f32_32x32x16_bf16 v[64:79], v[32:35], v[236:239], v[64:79]
    ds_read_b64_tr_b16 v[16:17], v2 offset:16384
    ds_read_b64_tr_b16 v[18:19], v2 offset:17408
    s_waitcnt lgkmcnt(6)
    v_mfma_f32_32x32x16_bf16 v[80:95], v[36:39], v[236:239], v[80:95]
    ds_read_b64_tr_b16 v[20:21], v3 offset:16384
    ds_read_b64_tr_b16 v[22:23], v3 offset:17408
    s_waitcnt lgkmcnt(6)
    v_mfma_f32_32x32x16_bf16 v[96:111], v[40:43], v[236:239], v[96:111]
    ds_read_b64_tr_b16 v[24:25], v4 offset:16384
    ds_read_b64_tr_b16 v[26:27], v4 offset:17408
    s_waitcnt lgkmcnt(6)
    v_mfma_f32_32x32x16_bf16 v[112:127], v[44:47], v[236:239], v[112:127]
    ds_read_b64_tr_b16 v[28:29], v5 offset:16384
    ds_read_b64_tr_b16 v[30:31], v5 offset:17408
    s_waitcnt lgkmcnt(6)
    v_mfma_f32_32x32x16_bf16 v[64:79], v[16:19], v[240:243], v[64:79]
    ds_read_b64_tr_b16 v[32:33], v2 offset:20480
    ds_read_b64_tr_b16 v[34:35], v2 offset:21504
    s_waitcnt lgkmcnt(6)
    v_mfma_f32_32x32x16_bf16 v[80:95], v[20:23], v[240:243], v[80:95]
    ds_read_b64_tr_b16 v[36:37], v3 offset:20480
    ds_read_b64_tr_b16 v[38:39], v3 offset:21504
    s_waitcnt lgkmcnt(6)
    v_mfma_f32_32x32x16_bf16 v[96:111], v[24:27], v[240:243], v[96:111]
    ds_read_b64_tr_b16 v[40:41], v4 offset:20480
    ds_read_b64_tr_b16 v[42:43], v4 offset:21504
    s_waitcnt lgkmcnt(6)
    v_mfma_f32_32x32x16_bf16 v[112:127], v[28:31], v[240:243], v[112:127]
    ds_read_b64_tr_b16 v[44:45], v5 offset:20480
    ds_read_b64_tr_b16 v[46:47], v5 offset:21504
    s_waitcnt lgkmcnt(6)
    v_mfma_f32_32x32x16_bf16 v[64:79], v[32:35], v[244:247], v[64:79]
    ds_read_b64_tr_b16 v[16:17], v2 offset:24576
    ds_read_b64_tr_b16 v[18:19], v2 offset:25600
    s_waitcnt lgkmcnt(6)
    v_mfma_f32_32x32x16_bf16 v[80:95], v[36:39], v[244:247], v[80:95]
    ds_read_b64_tr_b16 v[20:21], v3 offset:24576
    ds_read_b64_tr_b16 v[22:23], v3 offset:25600
    s_waitcnt lgkmcnt(6)
    v_mfma_f32_32x32x16_bf16 v[96:111], v[40:43], v[244:247], v[96:111]
    ds_read_b64_tr_b16 v[24:25], v4 offset:24576
    ds_read_b64_tr_b16 v[26:27], v4 offset:25600
    s_waitcnt lgkmcnt(6)
    v_mfma_f32_32x32x16_bf16 v[112:127], v[44:47], v[244:247], v[112:127]
    ds_read_b64_tr_b16 v[28:29], v5 offset:24576
    ds_read_b64_tr_b16 v[30:31], v5 offset:25600
    s_waitcnt lgkmcnt(6)
    v_mfma_f32_32x32x16_bf16 v[64:79], v[16:19], v[248:251], v[64:79]
    ds_read_b64_tr_b16 v[32:33], v2 offset:28672
    ds_read_b64_tr_b16 v[34:35], v2 offset:29696
    s_waitcnt lgkmcnt(6)
    v_mfma_f32_32x32x16_bf16 v[80:95], v[20:23], v[248:251], v[80:95]
    ds_read_b64_tr_b16 v[36:37], v3 offset:28672
    ds_read_b64_tr_b16 v[38:39], v3 offset:29696
    s_waitcnt lgkmcnt(6)
    v_mfma_f32_32x32x16_bf16 v[96:111], v[24:27], v[248:251], v[96:111]
    ds_read_b64_tr_b16 v[40:41], v4 offset:28672
    ds_read_b64_tr_b16 v[42:43], v4 offset:29696
    s_waitcnt lgkmcnt(6)
    v_mfma_f32_32x32x16_bf16 v[112:127], v[28:31], v[248:251], v[112:127]
    ds_read_b64_tr_b16 v[44:45], v5 offset:28672
    ds_read_b64_tr_b16 v[46:47], v5 offset:29696
    s_waitcnt lgkmcnt(6)
    v_mfma_f32_32x32x16_bf16 v[64:79], v[32:35], v[252:255], v[64:79]
    s_waitcnt lgkmcnt(4)
    v_mfma_f32_32x32x16_bf16 v[80:95], v[36:39], v[252:255], v[80:95]
    s_waitcnt lgkmcnt(2)
    v_mfma_f32_32x32x16_bf16 v[96:111], v[40:43], v[252:255], v[96:111]
    s_waitcnt lgkmcnt(0)
    v_mfma_f32_32x32x16_bf16 v[112:127], v[44:47], v[252:255], v[112:127]
    s_lshl_b32 s3, s16, 11
    s_sub_u32 s6, s34, s3
    s_add_u32 s6, s6, 32768
    s_add_u32 s7, s6, 4096
    s_lshl_b32 s4, s18, 19
    s_sub_u32 s5, s6, s4
    s_sub_u32 s5, s5, 2048
    s_cmp_eq_u32 s18, 0
    s_cbranch_scc1 L_own0
    s_sub_u32 s3, s18, 0
    s_and_b32 s3, s3, 3
    s_lshl_b32 s3, s3, 11
    s_add_u32 s3, s3, s5
    v_cvt_pk_bf16_f32 v192, v64, v65
    v_cvt_pk_bf16_f32 v193, v66, v67
    v_cvt_pk_bf16_f32 v194, v68, v69
    v_cvt_pk_bf16_f32 v195, v70, v71
    v_cvt_pk_bf16_f32 v196, v72, v73
    v_cvt_pk_bf16_f32 v197, v74, v75
    v_cvt_pk_bf16_f32 v198, v76, v77
    v_cvt_pk_bf16_f32 v199, v78, v79
    buffer_store_dwordx4 v[192:195], v1, s[44:47], s3 offen offset:0 sc1
    buffer_store_dwordx4 v[196:199], v1, s[44:47], s3 offen offset:1024 sc1
    s_branch L_nxt0
L_own0:
    v_mov_b32 v128, v64
    v_mov_b32 v129, v65
    v_mov_b32 v130, v66
    v_mov_b32 v131, v67
    v_mov_b32 v132, v68
    v_mov_b32 v133, v69
    v_mov_b32 v134, v70
    v_mov_b32 v135, v71
    v_mov_b32 v136, v72
    v_mov_b32 v137, v73
    v_mov_b32 v138, v74
    v_mov_b32 v139, v75
    v_mov_b32 v140, v76
    v_mov_b32 v141, v77
    v_mov_b32 v142, v78
    v_mov_b32 v143, v79
L_nxt0:
    s_add_u32 s5, s5, 524288
    s_cmp_eq_u32 s18, 1
    s_cbranch_scc1 L_own1
    s_sub_u32 s3, s18, 1
    s_and_b32 s3, s3, 3
    s_lshl_b32 s3, s3, 11
    s_add_u32 s3, s3, s5
    v_cvt_pk_bf16_f32 v200, v80, v81
    v_cvt_pk_bf16_f32 v201, v82, v83
    v_cvt_pk_bf16_f32 v202, v84, v85
    v_cvt_pk_bf16_f32 v203, v86, v87
    v_cvt_pk_bf16_f32 v204, v88, v89
    v_cvt_pk_bf16_f32 v205, v90, v91
    v_cvt_pk_bf16_f32 v206, v92, v93
    v_cvt_pk_bf16_f32 v207, v94, v95
    buffer_store_dwordx4 v[200:203], v1, s[44:47], s3 offen offset:0 sc1
    buffer_store_dwordx4 v[204:207], v1, s[44:47], s3 offen offset:1024 sc1
    s_branch L_nxt1
L_own1:
    v_mov_b32 v128, v80
    v_mov_b32 v129, v81
    v_mov_b32 v130, v82
    v_mov_b32 v131, v83
    v_mov_b32 v132, v84
    v_mov_b32 v133, v85
    v_mov_b32 v134, v86
    v_mov_b32 v135, v87
    v_mov_b32 v136, v88
    v_mov_b32 v137, v89
    v_mov_b32 v138, v90
    v_mov_b32 v139, v91
    v_mov_b32 v140, v92
    v_mov_b32 v141, v93
    v_mov_b32 v142, v94
    v_mov_b32 v143, v95
L_nxt1:
    s_add_u32 s5, s5, 524288
    s_cmp_eq_u32 s18, 2
    s_cbranch_scc1 L_own2
    s_sub_u32 s3, s18, 2
    s_and_b32 s3, s3, 3
    s_lshl_b32 s3, s3, 11
    s_add_u32 s3, s3, s5
    v_cvt_pk_bf16_f32 v208, v96, v97
    v_cvt_pk_bf16_f32 v209, v98, v99
    v_cvt_pk_bf16_f32 v210, v100, v101
    v_cvt_pk_bf16_f32 v211, v102, v103
    v_cvt_pk_bf16_f32 v212, v104, v105
    v_cvt_pk_bf16_f32 v213, v106, v107
    v_cvt_pk_bf16_f32 v214, v108, v109
    v_cvt_pk_bf16_f32 v215, v110, v111
    buffer_store_dwordx4 v[208:211], v1, s[44:47], s3 offen offset:0 sc1
    buffer_store_dwordx4 v[212:215], v1, s[44:47], s3 offen offset:1024 sc1
    s_branch L_nxt2
L_own2:
    v_mov_b32 v128, v96
    v_mov_b32 v129, v97
    v_mov_b32 v130, v98
    v_mov_b32 v131, v99
    v_mov_b32 v132, v100
    v_mov_b32 v133, v101
    v_mov_b32 v134, v102
    v_mov_b32 v135, v103
    v_mov_b32 v136, v104
    v_mov_b32 v137, v105
    v_mov_b32 v138, v106
    v_mov_b32 v139, v107
    v_mov_b32 v140, v108
    v_mov_b32 v141, v109
    v_mov_b32 v142, v110
    v_mov_b32 v143, v111
L_nxt2:
    s_add_u32 s5, s5, 524288
    s_cmp_eq_u32 s18, 3
    s_cbranch_scc1 L_own3
    s_sub_u32 s3, s18, 3
    s_and_b32 s3, s3, 3
    s_lshl_b32 s3, s3, 11
    s_add_u32 s3, s3, s5
    v_cvt_pk_bf16_f32 v216, v112, v113
    v_cvt_pk_bf16_f32 v217, v114, v115
    v_cvt_pk_bf16_f32 v218, v116, v117
    v_cvt_pk_bf16_f32 v219, v118, v119
    v_cvt_pk_bf16_f32 v220, v120, v121
    v_cvt_pk_bf16_f32 v221, v122, v123
    v_cvt_pk_bf16_f32 v222, v124, v125
    v_cvt_pk_bf16_f32 v223, v126, v127
    buffer_store_dwordx4 v[216:219], v1, s[44:47], s3 offen offset:0 sc1
    buffer_store_dwordx4 v[220:223], v1, s[44:47], s3 offen offset:1024 sc1
    s_branch L_nxt3
L_own3:
    v_mov_b32 v128, v112
    v_mov_b32 v129, v113
    v_mov_b32 v130, v114
    v_mov_b32 v131, v115
    v_mov_b32 v132, v116
    v_mov_b32 v133, v117
    v_mov_b32 v134, v118
    v_mov_b32 v135, v119
    v_mov_b32 v136, v120
    v_mov_b32 v137, v121
    v_mov_b32 v138, v122
    v_mov_b32 v139, v123
    v_mov_b32 v140, v124
    v_mov_b32 v141, v125
    v_mov_b32 v142, v126
    v_mov_b32 v143, v127
L_nxt3:
    s_add_u32 s5, s5, 524288
    buffer_load_dwordx4 v[144:147], v1, s[44:47], s6 offen offset:0 sc1
    buffer_load_dwordx4 v[148:151], v1, s[44:47], s6 offen offset:1024 sc1
    buffer_load_dwordx4 v[152:155], v1, s[44:47], s6 offen offset:2048 sc1
    buffer_load_dwordx4 v[156:159], v1, s[44:47], s6 offen offset:3072 sc1
    buffer_load_dwordx4 v[160:163], v1, s[44:47], s7 offen offset:0 sc1
    buffer_load_dwordx4 v[164:167], v1, s[44:47], s7 offen offset:1024 sc1
    v_and_b32 v11, 31, v0
    v_lshrrev_b32 v12, 5, v0
    v_lshlrev_b32 v12, 4, v12
    v_lshl_add_u32 v12, v11, 12, v12
    s_mov_b32 s30, 0xffff0000
    s_lshl_b32 s3, s23, 17
    s_lshl_b32 s4, s17, 11
    s_add_u32 s3, s3, s4
    s_lshl_b32 s4, s20, 8
    s_add_u32 s3, s3, s4
    s_lshl_b32 s4, s18, 6
    s_add_u32 s3, s3, s4
    s_waitcnt vmcnt(0)
    v_max3_u32 v14, v144, v145, v146
    v_max3_u32 v14, v14, v147, v148
    v_max3_u32 v14, v14, v149, v150
    v_max3_u32 v14, v14, v151, v152
    v_max3_u32 v14, v14, v153, v154
    v_max3_u32 v14, v14, v155, v156
    v_max3_u32 v14, v14, v157, v158
    v_max3_u32 v14, v14, v159, v160
    v_max3_u32 v14, v14, v161, v162
    v_max3_u32 v14, v14, v163, v164
    v_max3_u32 v14, v14, v165, v166
    v_max_u32 v14, v14, v167
    v_cmp_eq_u32 vcc, -1, v14
    s_cbranch_vccnz L_rtc
L_okc:
    v_lshlrev_b32 v168, 16, v144
    v_and_b32 v144, s30, v144
    v_lshlrev_b32 v169, 16, v145
    v_and_b32 v145, s30, v145
    v_lshlrev_b32 v170, 16, v146
    v_and_b32 v146, s30, v146
    v_lshlrev_b32 v171, 16, v147
    v_and_b32 v147, s30, v147
    v_lshlrev_b32 v172, 16, v148
    v_and_b32 v148, s30, v148
    v_lshlrev_b32 v173, 16, v149
    v_and_b32 v149, s30, v149
    v_lshlrev_b32 v174, 16, v150
    v_and_b32 v150, s30, v150
    v_lshlrev_b32 v175, 16, v151
    v_and_b32 v151, s30, v151
    v_lshlrev_b32 v176, 16, v152
    v_and_b32 v152, s30, v152
    v_lshlrev_b32 v177, 16, v153
    v_and_b32 v153, s30, v153
    v_lshlrev_b32 v178, 16, v154
    v_and_b32 v154, s30, v154
    v_lshlrev_b32 v179, 16, v155
    v_and_b32 v155, s30, v155
    v_lshlrev_b32 v180, 16, v156
    v_and_b32 v156, s30, v156
    v_lshlrev_b32 v181, 16, v157
    v_and_b32 v157, s30, v157
    v_lshlrev_b32 v182, 16, v158
    v_and_b32 v158, s30, v158
    v_lshlrev_b32 v183, 16, v159
    v_and_b32 v159, s30, v159
    v_lshlrev_b32 v184, 16, v160
    v_and_b32 v160, s30, v160
    v_lshlrev_b32 v185, 16, v161
    v_and_b32 v161, s30, v161
    v_lshlrev_b32 v186, 16, v162
    v_and_b32 v162, s30, v162
    v_lshlrev_b32 v187, 16, v163
    v_and_b32 v163, s30, v163
    v_lshlrev_b32 v188, 16, v164
    v_and_b32 v164, s30, v164
    v_lshlrev_b32 v189, 16, v165
    v_and_b32 v165, s30, v165
    v_lshlrev_b32 v190, 16, v166
    v_and_b32 v166, s30, v166
    v_lshlrev_b32 v191, 16, v167
    v_and_b32 v167, s30, v167
    v_add_f32 v128, v128, v168
    v_add_f32 v129, v129, v144
    v_add_f32 v130, v130, v169
    v_add_f32 v131, v131, v145
    v_add_f32 v132, v132, v170
    v_add_f32 v133, v133, v146
    v_add_f32 v134, v134, v171
    v_add_f32 v135, v135, v147
    v_add_f32 v136, v136, v172
    v_add_f32 v137, v137, v148
    v_add_f32 v138, v138, v173
    v_add_f32 v139, v139, v149
    v_add_f32 v140, v140, v174
    v_add_f32 v141, v141, v150
    v_add_f32 v142, v142, v175
    v_add_f32 v143, v143, v151
    v_add_f32 v128, v128, v176
    v_add_f32 v129, v129, v152
    v_add_f32 v130, v130, v177
    v_add_f32 v131, v131, v153
    v_add_f32 v132, v132, v178
    v_add_f32 v133, v133, v154
    v_add_f32 v134, v134, v179
    v_add_f32 v135, v135, v155
    v_add_f32 v136, v136, v180
    v_add_f32 v137, v137, v156
    v_add_f32 v138, v138, v181
    v_add_f32 v139, v139, v157
    v_add_f32 v140, v140, v182
    v_add_f32 v141, v141, v158
    v_add_f32 v142, v142, v183
    v_add_f32 v143, v143, v159
    v_add_f32 v128, v128, v184
    v_add_f32 v129, v129, v160
    v_add_f32 v130, v130, v185
    v_add_f32 v131, v131, v161
    v_add_f32 v132, v132, v186
    v_add_f32 v133, v133, v162
    v_add_f32 v134, v134, v187
    v_add_f32 v135, v135, v163
    v_add_f32 v136, v136, v188
    v_add_f32 v137, v137, v164
    v_add_f32 v138, v138, v189
    v_add_f32 v139, v139, v165
    v_add_f32 v140, v140, v190
    v_add_f32 v141, v141, v166
    v_add_f32 v142, v142, v191
    v_add_f32 v143, v143, v167
    v_cvt_pk_bf16_f32 v16, v128, v129
    v_cvt_pk_bf16_f32 v17, v130, v131
    v_cvt_pk_bf16_f32 v18, v132, v133
    v_cvt_pk_bf16_f32 v19, v134, v135
    v_cvt_pk_bf16_f32 v20, v136, v137
    v_cvt_pk_bf16_f32 v21, v138, v139
    v_cvt_pk_bf16_f32 v22, v140, v141
    v_cvt_pk_bf16_f32 v23, v142, v143
    buffer_store_dwordx4 v[16:19], v12, s[12:15], s3 offen
    buffer_store_dwordx4 v[20:23], v12, s[12:15], s3 offen offset:32
L_end:
    s_endpgm
L_rw0:
    s_sub_u32 s92, s92, 1
    s_cmp_lt_i32 s92, 0
    s_cbranch_scc1 L_rx0
    s_sleep 1
    ds_read_b32 v10, v11
    s_branch L_rc0
L_pca:
    s_waitcnt lgkmcnt(4)
    s_add_u32 s31, s31, 1
    s_cmp_lg_u32 s31, 1
    s_cbranch_scc1 L_pca0
    ds_read_b128 v[128:131], v56
    ds_read_b128 v[132:135], v57
    ds_read_b128 v[136:139], v58
    ds_read_b128 v[140:143], v59
    s_branch L_pra
L_pca0:
    s_cmp_lg_u32 s31, 2
    s_cbranch_scc1 L_pca1
    ds_read_b128 v[144:147], v56
    ds_read_b128 v[148:151], v57
    ds_read_b128 v[152:155], v58
    ds_read_b128 v[156:159], v59
    s_branch L_pra
L_pca1:
    s_cmp_lg_u32 s31, 3
    s_cbranch_scc1 L_pca2
    ds_read_b64_tr_b16 v[224:225], v60 offset:0
    ds_read_b64_tr_b16 v[226:227], v60 offset:2048
    ds_read_b64_tr_b16 v[232:233], v61 offset:0
    ds_read_b64_tr_b16 v[234:235], v61 offset:2048
    ds_read_b64_tr_b16 v[240:241], v62 offset:0
    ds_read_b64_tr_b16 v[242:243], v62 offset:2048
    ds_read_b64_tr_b16 v[248:249], v63 offset:0
    ds_read_b64_tr_b16 v[250:251], v63 offset:2048
    s_branch L_pra
L_pca2:
    ds_read_b64_tr_b16 v[228:229], v60 offset:0
    ds_read_b64_tr_b16 v[230:231], v60 offset:2048
    ds_read_b64_tr_b16 v[236:237], v61 offset:0
    ds_read_b64_tr_b16 v[238:239], v61 offset:2048
    ds_read_b64_tr_b16 v[244:245], v62 offset:0
    ds_read_b64_tr_b16 v[246:247], v62 offset:2048
    ds_read_b64_tr_b16 v[252:253], v63 offset:0
    ds_read_b64_tr_b16 v[254:255], v63 offset:2048
    s_branch L_pra
L_rw1:
    s_sub_u32 s92, s92, 1
    s_cmp_lt_i32 s92, 0
    s_cbranch_scc1 L_rx1
    s_sleep 1
    ds_read_b32 v10, v11
    s_branch L_rc1
L_pcb:
    s_waitcnt lgkmcnt(4)
    s_add_u32 s31, s31, 1
    ds_read_b64_tr_b16 v[228:229], v60 offset:0
    ds_read_b64_tr_b16 v[230:231], v60 offset:2048
    ds_read_b64_tr_b16 v[236:237], v61 offset:0
    ds_read_b64_tr_b16 v[238:239], v61 offset:2048
    ds_read_b64_tr_b16 v[244:245], v62 offset:0
    ds_read_b64_tr_b16 v[246:247], v62 offset:2048
    ds_read_b64_tr_b16 v[252:253], v63 offset:0
    ds_read_b64_tr_b16 v[254:255], v63 offset:2048
    s_branch L_prb
L_os0:
    buffer_store_dwordx4 v[128:131], v1, s[44:47], s34 offen offset:0 sc1
    buffer_store_dwordx4 v[132:135], v1, s[44:47], s34 offen offset:1024 sc1
    s_branch L_or0
L_os1:
    buffer_store_dwordx4 v[136:139], v1, s[44:47], s34 offen offset:2048 sc1
    buffer_store_dwordx4 v[140:143], v1, s[44:47], s34 offen offset:3072 sc1
    s_branch L_or1
L_os2:
    buffer_store_dwordx4 v[144:147], v1, s[44:47], s3 offen offset:0 sc1
    buffer_store_dwordx4 v[148:151], v1, s[44:47], s3 offen offset:1024 sc1
    s_branch L_or2
L_os3:
    buffer_store_dwordx4 v[152:155], v1, s[44:47], s3 offen offset:2048 sc1
    buffer_store_dwordx4 v[156:159], v1, s[44:47], s3 offen offset:3072 sc1
    s_branch L_or3
L_rw2:
    s_sub_u32 s92, s92, 1
    s_cmp_lt_i32 s92, 0
    s_cbranch_scc1 L_rx2
    s_sleep 1
    ds_read_b32 v10, v11
    s_branch L_rc2
L_fs:
    buffer_store_dword v7, v13, s[44:47], s56 offen sc1
    s_branch L_fe
L_fr1:
    s_sub_u32 s33, s33, 1
    s_cmp_lt_i32 s33, 0
    s_cbranch_scc1 L_fo1
    buffer_load_dword v8, v9, s[44:47], s57 offen sc1
    s_waitcnt vmcnt(0)
    v_cmp_eq_u32 vcc, -1, v8
    s_nop 0
    s_bitcmp1_b32 vcc_lo, s6
    s_cbranch_scc1 L_fr1
    s_branch L_fo1
L_rw3:
    s_sub_u32 s92, s92, 1
    s_cmp_lt_i32 s92, 0
    s_cbranch_scc1 L_rx3
    s_sleep 1
    ds_read_b32 v10, v11
    s_branch L_rc3
L_fr2:
    s_sub_u32 s33, s33, 1
    s_cmp_lt_i32 s33, 0
    s_cbranch_scc1 L_fo2
    buffer_load_dword v8, v9, s[44:47], s57 offen sc1
    s_waitcnt vmcnt(0)
    v_cmp_eq_u32 vcc, -1, v8
    s_nop 0
    s_bitcmp1_b32 vcc_lo, s8
    s_cbranch_scc1 L_fr2
    s_branch L_fo2
L_rw4:
    s_sub_u32 s92, s92, 1
    s_cmp_lt_i32 s92, 0
    s_cbranch_scc1 L_rx4
    s_sleep 1
    ds_read_b32 v10, v11
    s_branch L_rc4
L_fr3:
    s_sub_u32 s33, s33, 1
    s_cmp_lt_i32 s33, 0
    s_cbranch_scc1 L_fo3
    buffer_load_dword v8, v9, s[44:47], s57 offen sc1
    s_waitcnt vmcnt(0)
    v_cmp_eq_u32 vcc, -1, v8
    s_nop 0
    s_bitcmp1_b32 vcc_lo, s10
    s_cbranch_scc1 L_fr3
    s_branch L_fo3
L_rw5:
    s_sub_u32 s92, s92, 1
    s_cmp_lt_i32 s92, 0
    s_cbranch_scc1 L_rx5
    s_sleep 1
    ds_read_b32 v10, v11
    s_branch L_rc5
L_fr4:
    s_sub_u32 s33, s33, 1
    s_cmp_lt_i32 s33, 0
    s_cbranch_scc1 L_fo4
    buffer_load_dword v8, v9, s[44:47], s57 offen sc1
    s_waitcnt vmcnt(0)
    v_cmp_eq_u32 vcc, -1, v8
    s_nop 0
    s_bitcmp1_b32 vcc_lo, s4
    s_cbranch_scc1 L_fr4
    s_branch L_fo4
L_rw6:
    s_sub_u32 s92, s92, 1
    s_cmp_lt_i32 s92, 0
    s_cbranch_scc1 L_rx6
    s_sleep 1
    ds_read_b32 v10, v11
    s_branch L_rc6
L_fr5:
    s_sub_u32 s33, s33, 1
    s_cmp_lt_i32 s33, 0
    s_cbranch_scc1 L_fo5
    buffer_load_dword v8, v9, s[44:47], s57 offen sc1
    s_waitcnt vmcnt(0)
    v_cmp_eq_u32 vcc, -1, v8
    s_nop 0
    s_bitcmp1_b32 vcc_lo, s6
    s_cbranch_scc1 L_fr5
    s_branch L_fo5
L_rw7:
    s_sub_u32 s92, s92, 1
    s_cmp_lt_i32 s92, 0
    s_cbranch_scc1 L_rx7
    s_sleep 1
    ds_read_b32 v10, v11
    s_branch L_rc7
L_fr6:
    s_sub_u32 s33, s33, 1
    s_cmp_lt_i32 s33, 0
    s_cbranch_scc1 L_fo6
    buffer_load_dword v8, v9, s[44:47], s57 offen sc1
    s_waitcnt vmcnt(0)
    v_cmp_eq_u32 vcc, -1, v8
    s_nop 0
    s_bitcmp1_b32 vcc_lo, s8
    s_cbranch_scc1 L_fr6
    s_branch L_fo6
L_rw8:
    s_sub_u32 s92, s92, 1
    s_cmp_lt_i32 s92, 0
    s_cbranch_scc1 L_rx8
    s_sleep 1
    ds_read_b32 v10, v11
    s_branch L_rc8
L_fr7:
    s_sub_u32 s33, s33, 1
    s_cmp_lt_i32 s33, 0
    s_cbranch_scc1 L_fo7
    buffer_load_dword v8, v9, s[44:47], s57 offen sc1
    s_waitcnt vmcnt(0)
    v_cmp_eq_u32 vcc, -1, v8
    s_nop 0
    s_bitcmp1_b32 vcc_lo, s10
    s_cbranch_scc1 L_fr7
    s_branch L_fo7
L_rw9:
    s_sub_u32 s92, s92, 1
    s_cmp_lt_i32 s92, 0
    s_cbranch_scc1 L_rx9
    s_sleep 1
    ds_read_b32 v10, v11
    s_branch L_rc9
L_rtc:
    s_sub_u32 s33, s33, 1
    s_cmp_lt_i32 s33, 0
    s_cbranch_scc1 L_okc
    buffer_load_dwordx4 v[144:147], v1, s[44:47], s6 offen offset:0 sc1
    buffer_load_dwordx4 v[148:151], v1, s[44:47], s6 offen offset:1024 sc1
    buffer_load_dwordx4 v[152:155], v1, s[44:47], s6 offen offset:2048 sc1
    buffer_load_dwordx4 v[156:159], v1, s[44:47], s6 offen offset:3072 sc1
    buffer_load_dwordx4 v[160:163], v1, s[44:47], s7 offen offset:0 sc1
    buffer_load_dwordx4 v[164:167], v1, s[44:47], s7 offen offset:1024 sc1
    s_waitcnt vmcnt(0)
    v_max3_u32 v14, v144, v145, v146
    v_max3_u32 v14, v14, v147, v148
    v_max3_u32 v14, v14, v149, v150
    v_max3_u32 v14, v14, v151, v152
    v_max3_u32 v14, v14, v153, v154
    v_max3_u32 v14, v14, v155, v156
    v_max3_u32 v14, v14, v157, v158
    v_max3_u32 v14, v14, v159, v160
    v_max3_u32 v14, v14, v161, v162
    v_max3_u32 v14, v14, v163, v164
    v_max3_u32 v14, v14, v165, v166
    v_max_u32 v14, v14, v167
    v_cmp_eq_u32 vcc, -1, v14
    s_cbranch_vccnz L_rtc
    s_branch L_okc
.section .rodata,"a"
.p2align 6
.amdhsa_kernel concat_heads__gqa_block_cached__mha_block_cached__near_ridge_kernel
  .amdhsa_next_free_vgpr 256
  .amdhsa_next_free_sgpr 102
  .amdhsa_accum_offset 256
  .amdhsa_group_segment_fixed_size 0
  .amdhsa_kernarg_size 104
  .amdhsa_user_sgpr_count 2
  .amdhsa_user_sgpr_kernarg_segment_ptr 1
  .amdhsa_system_sgpr_workgroup_id_x 1
.end_amdhsa_kernel
```
